```python
import torch

def _softmax(x, axis=-1):
    return torch.softmax(x, dim=axis)
def _gelu(x):
    return torch.nn.functional.gelu(x, approximate="tanh")
def _silu(x):
    return torch.nn.functional.silu(x)
def _sigmoid(x):
    return torch.sigmoid(x)
def _layernorm(x, axis=-1, eps=1e-5):
    m = x.mean(dim=axis, keepdim=True)
    v = x.var(dim=axis, keepdim=True, unbiased=False)
    return (x - m) / torch.sqrt(v + eps)
def _scatter_add(tgt, idx, src, axis=0):
    return tgt.clone().index_add_(axis, idx, src)
def _segment_sum(src, seg, n):
    out = torch.zeros((n,) + src.shape[1:], dtype=src.dtype)
    return out.index_add_(0, seg, src)
def _pad(x, pw):
    flat = tuple(v for pair in reversed(pw) for v in pair)
    return torch.nn.functional.pad(x, flat)

kernel_name = 'gated_mix__linear_kernel_hedgehog__ssm_conv_s4__prompt'

def setup_inputs():

    _w = (lambda a: (lambda t: t.to(torch.bfloat16) if t.is_floating_point() else t)(torch.as_tensor(a)))
    def _A_setup():
        B, S, D, H = 1, 2048, 512, 32
        Dh = D // H
        return {
            "x": _w((lambda *s: torch.randn(*s, dtype=torch.bfloat16) * 0.05)(B, S, D)),
            "wqkv": _w((lambda *s: torch.randn(*s, dtype=torch.bfloat16) * 0.8)(D, 3 * D)),
            "w_phi": _w((lambda *s: torch.randn(*s, dtype=torch.bfloat16) * 0.8)(H, Dh, Dh) * (Dh ** -0.5)),
            "wo": _w((lambda *s: torch.randn(*s, dtype=torch.bfloat16) * 0.05)(D, D)),
        }
    _A_in = _A_setup()

    def _B_setup():
        B, L, D, N = 1, 2048, 512, 128
        A_re = -(lambda _x: torch.exp(torch.as_tensor(_x)))((lambda *s: torch.randn(*s, dtype=torch.bfloat16) * 3.2)(D, N))
        A_im = torch.pi * (lambda *s: torch.randn(*s, dtype=torch.bfloat16) * 0.05)(D, N)
        B_re = (lambda *s: torch.randn(*s, dtype=torch.bfloat16) * 0.2)(D, N)
        B_im = (lambda *s: torch.randn(*s, dtype=torch.bfloat16) * 0.2)(D, N)
        C_re = (lambda *s: torch.randn(*s, dtype=torch.bfloat16) * 0.2)(D, N)
        C_im = (lambda *s: torch.randn(*s, dtype=torch.bfloat16) * 0.2)(D, N)
        log_dt = (lambda *s: torch.randn(*s, dtype=torch.bfloat16) * 0.05)(D) * 0.5 - 4.0
        Dskip = (lambda *s: torch.randn(*s, dtype=torch.bfloat16) * 0.05)(D)
        return {
            "u": _w((lambda *s: torch.randn(*s, dtype=torch.bfloat16) * 0.05)(B, L, D)),
            "A_re": _w(A_re),
            "A_im": _w(A_im),
            "B_re": _w(B_re),
            "B_im": _w(B_im),
            "C_re": _w(C_re),
            "C_im": _w(C_im),
            "log_dt": _w(log_dt),
            "Dskip": _w(Dskip),
        }
    _B_in = _B_setup()

    return {
        "A_x": _A_in["x"],
        "A_wqkv": _A_in["wqkv"],
        "A_w_phi": _A_in["w_phi"],
        "A_wo": _A_in["wo"],
        "B_u": _B_in["u"],
        "B_A_re": _B_in["A_re"],
        "B_A_im": _B_in["A_im"],
        "B_B_re": _B_in["B_re"],
        "B_B_im": _B_in["B_im"],
        "B_C_re": _B_in["C_re"],
        "B_C_im": _B_in["C_im"],
        "B_log_dt": _B_in["log_dt"],
        "B_Dskip": _B_in["Dskip"],
        "gate_w": _w((lambda *s: torch.randn(*s, dtype=torch.bfloat16) * 0.05)(512) * 16.0),
    }

def reference(A_x, A_wqkv, A_w_phi, A_wo, B_u, B_A_re, B_A_im, B_B_re, B_B_im, B_C_re, B_C_im, B_log_dt, B_Dskip, gate_w):
    def _A_ref(x, wqkv, w_phi, wo):
        B, S, D = x.shape
        H = 32; Dh = D // H
        qkv = (lambda x, *d: x.permute(*d))((x @ wqkv).reshape(B, S, 3, H, Dh), 2, 0, 3, 1, 4)
        q, k, v = qkv[0], qkv[1], qkv[2]
        pq = torch.einsum("bhsd,hdf->bhsf", q, w_phi)
        pk = torch.einsum("bhsd,hdf->bhsf", k, w_phi)
        phi_q = torch.concatenate([_softmax(pq, axis=-1), _softmax(-pq, axis=-1)], axis=-1)
        phi_k = torch.concatenate([_softmax(pk, axis=-1), _softmax(-pk, axis=-1)], axis=-1)
        kv = torch.einsum("bhsf,bhsd->bhfd", phi_k, v)
        z  = torch.einsum("bhsf->bhf", phi_k)
        num = torch.einsum("bhqf,bhfd->bhqd", phi_q, kv)
        den = torch.einsum("bhqf,bhf->bhq", phi_q, z)[..., None] + 1e-6
        o = num / den
        return (lambda x, *d: x.permute(*d))(o, 0, 2, 1, 3).reshape(B, S, D) @ wo

    def _B_ref(u, A_re, A_im, B_re, B_im, C_re, C_im, log_dt, Dskip):
        Bsz, L, D = u.shape
        dt = torch.exp(log_dt)[:, None]
        A = A_re + 1j * A_im
        Bc = B_re + 1j * B_im
        Cc = C_re + 1j * C_im
        logdA = dt * A
        dB = dt * Bc
        l = (lambda x, dt: x.to(dt))(torch.arange(L), A_re.dtype)
        P = torch.exp(logdA[:, :, None] * l[None, None, :])
        K = torch.einsum("dn,dnl,dn->dl", Cc, P, dB).real
        L2 = 2 * L
        Kp = _pad(K, ((0, 0), (0, L)))
        up = (lambda x, *d: x.permute(*d))(u, 0, 2, 1)
        up = _pad(up, ((0, 0), (0, 0), (0, L)))
        Kf = (lambda x, axes=(-2,-1): torch.fft.rfft2(x.float(), dim=axes))(Kp[:, None, :], axes=(-2, -1))
        Uf = (lambda x, axes=(-2,-1): torch.fft.rfft2(x.float(), dim=axes))(up[:, :, None, :], axes=(-2, -1))
        Yf = Uf * Kf[None, :, :, :]
        y = (lambda x, s, axes=(-2,-1): torch.fft.irfft2(x, s=s, dim=axes).to(torch.bfloat16))(Yf, (1, L2), axes=(-2, -1))[:, :, 0, :L]
        y = (lambda x, *d: x.permute(*d))(y, 0, 2, 1) + u * Dskip[None, None, :]
        return y

    x = A_x
    g = _sigmoid((x * gate_w).sum(-1, keepdims=True))
    a = _A_ref(x, A_wqkv, A_w_phi, A_wo)
    b = _B_ref(x, B_A_re, B_A_im, B_B_re, B_B_im, B_C_re, B_C_im, B_log_dt, B_Dskip)
    return g * a + (1 - g) * b
```

```asm
; @launch grid=(256,1,1) block=(512,1,1) lds=163840
.amdgcn_target "amdgcn-amd-amdhsa--gfx950"
.text
.globl gated_mix__linear_kernel_hedgehog__ssm_conv_s4__prompt_kernel
.p2align 8
.type gated_mix__linear_kernel_hedgehog__ssm_conv_s4__prompt_kernel,@function
gated_mix__linear_kernel_hedgehog__ssm_conv_s4__prompt_kernel:
  s_load_dwordx16 s[36:51], s[0:1], 0
  s_load_dwordx16 s[52:67], s[0:1], 64
  s_load_dwordx2 s[68:69], s[0:1], 128
  s_cmp_ge_u32 s2, 256
  s_cbranch_scc1 K_end
  s_and_b32 s70, s2, 7
  s_lshr_b32 s71, s2, 3
  s_lshl_b32 s94, s70, 3
  s_lshr_b32 s3, s71, 2
  s_add_u32 s94, s94, s3
  s_and_b32 s95, s71, 3
  s_cmp_ge_u32 s71, 16
  s_cbranch_scc1 K_conv
  v_lshrrev_b32 v2, 6, v0
  v_and_b32 v1, 63, v0
  v_readfirstlane_b32 s72, v2
  s_lshr_b32 s73, s70, 1
  s_lshl_b32 s73, s73, 2
  s_lshr_b32 s76, s71, 2
  s_add_u32 s73, s73, s76
  s_and_b32 s74, s70, 1
  s_lshl_b32 s74, s74, 2
  s_and_b32 s77, s71, 3
  s_add_u32 s74, s74, s77
  s_and_b32 s80, s72, 3
  v_lshlrev_b32 v5, 4, v1
  s_waitcnt lgkmcnt(0)
  s_mov_b32 s8, s36
  s_mov_b32 s9, s37
  s_mov_b32 s10, 0x200000
  s_mov_b32 s11, 0x20000
  s_mov_b32 s4, s38
  s_mov_b32 s5, s39
  s_mov_b32 s6, 0x180000
  s_mov_b32 s7, 0x20000
  s_cmp_lt_u32 s72, 4
  s_cbranch_scc1 G_compute
  s_lshl_b32 s75, s80, 12
  v_lshrrev_b32 v2, 3, v1
  v_and_b32 v3, 7, v1
  v_lshrrev_b32 v4, 1, v2
  v_xor_b32 v4, v4, v3
  v_lshlrev_b32 v4, 4, v4
  v_lshl_add_u32 v80, v2, 10, v4
  s_lshl_b32 s76, s73, 17
  s_lshl_b32 s77, s80, 15
  s_add_u32 s76, s76, s77
  v_add_u32 v80, s76, v80
  v_xor_b32 v81, 64, v80
  s_add_u32 m0, s75, 0
  s_mov_b32 s81, 0
  buffer_load_dwordx4 v80, s[8:11], s81 offen lds
  s_add_u32 m0, s75, 1024
  s_mov_b32 s81, 8192
  buffer_load_dwordx4 v81, s[8:11], s81 offen lds
  s_add_u32 m0, s75, 2048
  s_mov_b32 s81, 16384
  buffer_load_dwordx4 v80, s[8:11], s81 offen lds
  s_add_u32 m0, s75, 3072
  s_mov_b32 s81, 24576
  buffer_load_dwordx4 v81, s[8:11], s81 offen lds
  v_lshlrev_b32 v4, 1, v2
  v_and_b32 v4, 4, v4
  v_xor_b32 v4, v4, v3
  v_lshlrev_b32 v4, 4, v4
  s_movk_i32 s76, 3072
  v_mad_u32_u24 v4, v2, s76, v4
  s_and_b32 s76, s80, 1
  s_mul_i32 s76, s76, 98304
  s_lshl_b32 s77, s74, 7
  s_add_u32 s76, s76, s77
  s_lshr_b32 s78, s80, 1
  s_add_u32 s78, s78, 1
  s_lshl_b32 s78, s78, 10
  s_add_u32 s76, s76, s78
  v_add_u32 v82, s76, v4
  s_add_u32 m0, s75, 16384
  s_mov_b32 s81, 0
  buffer_load_dwordx4 v82, s[4:7], s81 offen lds
  s_add_u32 m0, s75, 17408
  s_mov_b32 s81, 24576
  buffer_load_dwordx4 v82, s[4:7], s81 offen lds
  s_add_u32 m0, s75, 18432
  s_mov_b32 s81, 49152
  buffer_load_dwordx4 v82, s[4:7], s81 offen lds
  s_add_u32 m0, s75, 19456
  s_mov_b32 s81, 73728
  buffer_load_dwordx4 v82, s[4:7], s81 offen lds
  v_mov_b32 v83, v4
  s_and_b32 s88, s72, 1
  s_lshl_b32 s88, s88, 1
  s_lshr_b32 s76, s80, 1
  s_add_u32 s88, s88, s76
  s_lshr_b32 s89, s72, 2
  s_mov_b32 s12, s40
  s_mov_b32 s13, s41
  s_mov_b32 s14, 0x4000
  s_mov_b32 s15, 0x20000
  s_lshl_b32 s76, s74, 11
  s_lshl_b32 s77, s89, 10
  s_add_u32 s76, s76, s77
  buffer_load_dwordx4 v[98:101], v5, s[12:15], s76 offen
  s_add_u32 s24, s68, 0x600000
  s_addc_u32 s25, s69, 0
  s_mov_b32 s26, 0x1b000
  s_mov_b32 s27, 0x20000
  s_cmp_lg_u32 s73, 0
  s_cbranch_scc1 G_nozero
  v_mov_b32 v94, 0
  v_mov_b32 v95, 0
  v_mov_b32 v96, 0
  v_mov_b32 v97, 0
  s_lshl_b32 s76, s74, 13
  s_lshl_b32 s77, s80, 11
  s_add_u32 s76, s76, s77
  buffer_store_dwordx4 v[94:97], v5, s[24:27], s76 offen sc1
  buffer_store_dwordx4 v[94:97], v5, s[24:27], s76 offen offset:1024 sc1
  s_mul_i32 s76, s74, 5120
  s_lshl_b32 s77, s80, 10
  s_add_u32 s76, s76, s77
  s_add_u32 s76, s76, 69632
  buffer_store_dwordx4 v[94:97], v5, s[24:27], s76 offen sc1
  s_cmp_gt_u32 s80, 1
  s_cbranch_scc1 G_nozero
  s_add_u32 s76, s76, 4096
  s_cmp_eq_u32 s80, 0
  s_cbranch_scc1 G_zflag
  s_lshl_b32 s76, s74, 9
  s_add_u32 s76, s76, 65536
  s_mov_b32 exec_hi, 0
G_zflag:
  buffer_store_dwordx4 v[94:97], v5, s[24:27], s76 offen sc1
  s_mov_b64 exec, -1
G_nozero:
  s_add_u32 m0, s75, 32768
  s_mov_b32 s81, 128
  buffer_load_dwordx4 v80, s[8:11], s81 offen lds
  s_add_u32 m0, s75, 33792
  s_mov_b32 s81, 8320
  buffer_load_dwordx4 v81, s[8:11], s81 offen lds
  s_add_u32 m0, s75, 34816
  s_mov_b32 s81, 16512
  buffer_load_dwordx4 v80, s[8:11], s81 offen lds
  s_add_u32 m0, s75, 35840
  s_mov_b32 s81, 24704
  buffer_load_dwordx4 v81, s[8:11], s81 offen lds
  s_add_u32 m0, s75, 49152
  s_mov_b32 s81, 196608
  buffer_load_dwordx4 v82, s[4:7], s81 offen lds
  s_add_u32 m0, s75, 50176
  s_mov_b32 s81, 221184
  buffer_load_dwordx4 v82, s[4:7], s81 offen lds
  s_add_u32 m0, s75, 51200
  s_mov_b32 s81, 245760
  buffer_load_dwordx4 v82, s[4:7], s81 offen lds
  s_add_u32 m0, s75, 52224
  s_mov_b32 s81, 270336
  buffer_load_dwordx4 v82, s[4:7], s81 offen lds
  s_waitcnt vmcnt(8)
  s_lshl_b32 s79, s72, 10
  s_add_u32 s79, s79, 131072
  v_add_u32 v2, s79, v5
  ds_write_b128 v2, v[98:101]
  v_bfe_u32 v2, v1, 2, 2
  v_lshrrev_b32 v4, 5, v1
  v_lshl_add_u32 v2, v4, 2, v2
  v_lshlrev_b32 v2, 5, v2
  v_and_b32 v4, 1, v1
  v_lshl_add_u32 v2, v4, 9, v2
  v_bfe_u32 v4, v1, 1, 1
  v_lshl_add_u32 v2, v4, 3, v2
  v_bfe_u32 v4, v1, 4, 1
  v_lshl_add_u32 v2, v4, 4, v2
  v_add_u32 v2, s79, v2
  ds_read_b64_tr_b16 v[98:99], v2 offset:0
  ds_read_b64_tr_b16 v[100:101], v2 offset:256
  s_waitcnt lgkmcnt(0)
  v_bfe_i32 v2, v1, 2, 1
  v_and_b32 v12, v2, v98
  v_and_b32 v13, v2, v99
  v_and_b32 v14, v2, v100
  v_and_b32 v15, v2, v101
  v_xor_b32 v8, v12, v98
  v_xor_b32 v9, v13, v99
  v_xor_b32 v10, v14, v100
  v_xor_b32 v11, v15, v101
  s_barrier
  s_add_u32 m0, s75, 65536
  s_mov_b32 s81, 256
  buffer_load_dwordx4 v80, s[8:11], s81 offen lds
  s_add_u32 m0, s75, 66560
  s_mov_b32 s81, 8448
  buffer_load_dwordx4 v81, s[8:11], s81 offen lds
  s_add_u32 m0, s75, 67584
  s_mov_b32 s81, 16640
  buffer_load_dwordx4 v80, s[8:11], s81 offen lds
  s_add_u32 m0, s75, 68608
  s_mov_b32 s81, 24832
  buffer_load_dwordx4 v81, s[8:11], s81 offen lds
  s_add_u32 m0, s75, 81920
  s_mov_b32 s81, 393216
  buffer_load_dwordx4 v82, s[4:7], s81 offen lds
  s_add_u32 m0, s75, 82944
  s_mov_b32 s81, 417792
  buffer_load_dwordx4 v82, s[4:7], s81 offen lds
  s_add_u32 m0, s75, 83968
  s_mov_b32 s81, 442368
  buffer_load_dwordx4 v82, s[4:7], s81 offen lds
  s_add_u32 m0, s75, 84992
  s_mov_b32 s81, 466944
  buffer_load_dwordx4 v82, s[4:7], s81 offen lds
  s_mul_i32 s76, s80, 196608
  s_lshl_b32 s77, s74, 7
  s_add_u32 s76, s76, s77
  v_add_u32 v83, s76, v83
  s_mov_b32 s20, s68
  s_mov_b32 s21, s69
  s_mov_b32 s22, 0x400000
  s_mov_b32 s23, 0x20000
  s_mov_b32 s90, 0x3fb8aa3b
  s_mov_b32 s91, 0x3fb8aa3b
  v_and_b32 v4, 31, v1
  v_lshlrev_b32 v7, 6, v4
  v_bfe_u32 v4, v1, 1, 2
  v_lshl_add_u32 v7, v4, 4, v7
  v_lshrrev_b32 v4, 5, v1
  v_lshl_add_u32 v7, v4, 11, v7
  s_lshl_b32 s76, s88, 13
  s_lshl_b32 s77, s89, 12
  s_add_u32 s76, s76, s77
  s_add_u32 s76, s76, 32768
  v_add_u32 v7, s76, v7
  s_waitcnt vmcnt(8)
  s_barrier
  s_add_u32 m0, s75, 98304
  s_mov_b32 s81, 384
  buffer_load_dwordx4 v80, s[8:11], s81 offen lds
  s_add_u32 m0, s75, 99328
  s_mov_b32 s81, 8576
  buffer_load_dwordx4 v81, s[8:11], s81 offen lds
  s_add_u32 m0, s75, 100352
  s_mov_b32 s81, 16768
  buffer_load_dwordx4 v80, s[8:11], s81 offen lds
  s_add_u32 m0, s75, 101376
  s_mov_b32 s81, 24960
  buffer_load_dwordx4 v81, s[8:11], s81 offen lds
  s_add_u32 m0, s75, 114688
  s_mov_b32 s81, 589824
  buffer_load_dwordx4 v82, s[4:7], s81 offen lds
  s_add_u32 m0, s75, 115712
  s_mov_b32 s81, 614400
  buffer_load_dwordx4 v82, s[4:7], s81 offen lds
  s_add_u32 m0, s75, 116736
  s_mov_b32 s81, 638976
  buffer_load_dwordx4 v82, s[4:7], s81 offen lds
  s_add_u32 m0, s75, 117760
  s_mov_b32 s81, 663552
  buffer_load_dwordx4 v82, s[4:7], s81 offen lds
  s_cmp_lg_u32 s73, 0
  s_cbranch_scc1 G_nopub
  s_cmp_lg_u32 s72, 4
  s_cbranch_scc1 G_nopub
  s_mov_b32 s16, s66
  s_mov_b32 s17, s67
  s_mov_b32 s18, 0x100
  s_mov_b32 s19, 0x20000
  v_mov_b32 v2, 1
  s_mov_b64 exec, 1
  buffer_atomic_add v2, off, s[16:19], 0 sc1
  s_mov_b64 exec, -1
G_nopub:
  s_waitcnt vmcnt(8)
  s_barrier
  s_add_u32 m0, s75, 131072
  s_mov_b32 s81, 512
  buffer_load_dwordx4 v80, s[8:11], s81 offen lds
  s_add_u32 m0, s75, 132096
  s_mov_b32 s81, 8704
  buffer_load_dwordx4 v81, s[8:11], s81 offen lds
  s_add_u32 m0, s75, 133120
  s_mov_b32 s81, 16896
  buffer_load_dwordx4 v80, s[8:11], s81 offen lds
  s_add_u32 m0, s75, 134144
  s_mov_b32 s81, 25088
  buffer_load_dwordx4 v81, s[8:11], s81 offen lds
  s_add_u32 m0, s75, 147456
  s_mov_b32 s81, 786432
  buffer_load_dwordx4 v82, s[4:7], s81 offen lds
  s_add_u32 m0, s75, 148480
  s_mov_b32 s81, 811008
  buffer_load_dwordx4 v82, s[4:7], s81 offen lds
  s_add_u32 m0, s75, 149504
  s_mov_b32 s81, 835584
  buffer_load_dwordx4 v82, s[4:7], s81 offen lds
  s_add_u32 m0, s75, 150528
  s_mov_b32 s81, 860160
  buffer_load_dwordx4 v82, s[4:7], s81 offen lds
  s_mov_b32 s28, s42
  s_mov_b32 s29, s43
  s_mov_b32 s30, 0x80000
  s_mov_b32 s31, 0x20000
  s_mov_b32 s32, s62
  s_mov_b32 s33, s63
  s_mov_b32 s34, 0x400
  s_mov_b32 s35, 0x20000
  v_lshrrev_b32 v2, 4, v1
  v_lshlrev_b32 v84, 2, v2
  v_xor_b32 v84, v84, v1
  v_and_b32 v84, 15, v84
  v_lshlrev_b32 v84, 4, v84
  v_lshl_add_u32 v84, v2, 10, v84
  v_lshrrev_b32 v3, 5, v1
  v_bfe_u32 v2, v1, 2, 2
  v_lshl_add_u32 v2, v3, 3, v2
  v_lshlrev_b32 v90, 6, v2
  v_and_b32 v4, 3, v1
  v_lshl_add_u32 v90, v4, 3, v90
  v_bfe_u32 v4, v1, 3, 1
  v_lshlrev_b32 v4, 4, v4
  v_xor_b32 v90, v90, v4
  s_lshl_b32 s76, s80, 5
  s_and_b32 s76, s76, 32
  s_lshr_b32 s77, s80, 1
  s_lshl_b32 s77, s77, 11
  s_add_u32 s76, s76, s77
  s_add_u32 s76, s76, 16384
  v_add_u32 v88, s76, v90
  v_xor_b32 v89, 32, v88
  v_bfe_u32 v2, v1, 4, 1
  v_lshl_add_u32 v90, v2, 5, v90
  s_lshl_b32 s76, s80, 11
  s_add_u32 s76, s76, 32768
  v_add_u32 v90, s76, v90
  v_xor_b32 v91, 32, v90
  s_mov_b32 s76, 0x3f803f80
  v_mul_lo_u32 v86, v2, s76
  v_add_u32 v85, -1, v2
  v_and_b32 v92, 31, v1
  v_lshlrev_b32 v92, 2, v92
  v_lshl_add_u32 v92, v3, 9, v92
  v_lshlrev_b32 v93, 2, v1
  s_waitcnt vmcnt(8)
  s_barrier
  s_add_u32 m0, s75, 0
  s_mov_b32 s81, 640
  buffer_load_dwordx4 v80, s[8:11], s81 offen lds
  s_add_u32 m0, s75, 1024
  s_mov_b32 s81, 8832
  buffer_load_dwordx4 v81, s[8:11], s81 offen lds
  s_add_u32 m0, s75, 2048
  s_mov_b32 s81, 17024
  buffer_load_dwordx4 v80, s[8:11], s81 offen lds
  s_add_u32 m0, s75, 3072
  s_mov_b32 s81, 25216
  buffer_load_dwordx4 v81, s[8:11], s81 offen lds
  s_add_u32 m0, s75, 16384
  s_mov_b32 s81, 983040
  buffer_load_dwordx4 v82, s[4:7], s81 offen lds
  s_add_u32 m0, s75, 17408
  s_mov_b32 s81, 1007616
  buffer_load_dwordx4 v82, s[4:7], s81 offen lds
  s_add_u32 m0, s75, 18432
  s_mov_b32 s81, 1032192
  buffer_load_dwordx4 v82, s[4:7], s81 offen lds
  s_add_u32 m0, s75, 19456
  s_mov_b32 s81, 1056768
  buffer_load_dwordx4 v82, s[4:7], s81 offen lds
  s_waitcnt vmcnt(8)
  s_barrier
  s_add_u32 m0, s75, 32768
  s_mov_b32 s81, 768
  buffer_load_dwordx4 v80, s[8:11], s81 offen lds
  s_add_u32 m0, s75, 33792
  s_mov_b32 s81, 8960
  buffer_load_dwordx4 v81, s[8:11], s81 offen lds
  s_add_u32 m0, s75, 34816
  s_mov_b32 s81, 17152
  buffer_load_dwordx4 v80, s[8:11], s81 offen lds
  s_add_u32 m0, s75, 35840
  s_mov_b32 s81, 25344
  buffer_load_dwordx4 v81, s[8:11], s81 offen lds
  s_add_u32 m0, s75, 49152
  s_mov_b32 s81, 1179648
  buffer_load_dwordx4 v82, s[4:7], s81 offen lds
  s_add_u32 m0, s75, 50176
  s_mov_b32 s81, 1204224
  buffer_load_dwordx4 v82, s[4:7], s81 offen lds
  s_add_u32 m0, s75, 51200
  s_mov_b32 s81, 1228800
  buffer_load_dwordx4 v82, s[4:7], s81 offen lds
  s_add_u32 m0, s75, 52224
  s_mov_b32 s81, 1253376
  buffer_load_dwordx4 v82, s[4:7], s81 offen lds
  s_waitcnt vmcnt(8)
  s_barrier
  s_add_u32 m0, s75, 65536
  s_mov_b32 s81, 896
  buffer_load_dwordx4 v80, s[8:11], s81 offen lds
  s_add_u32 m0, s75, 66560
  s_mov_b32 s81, 9088
  buffer_load_dwordx4 v81, s[8:11], s81 offen lds
  s_add_u32 m0, s75, 67584
  s_mov_b32 s81, 17280
  buffer_load_dwordx4 v80, s[8:11], s81 offen lds
  s_add_u32 m0, s75, 68608
  s_mov_b32 s81, 25472
  buffer_load_dwordx4 v81, s[8:11], s81 offen lds
  s_add_u32 m0, s75, 81920
  s_mov_b32 s81, 1376256
  buffer_load_dwordx4 v82, s[4:7], s81 offen lds
  s_add_u32 m0, s75, 82944
  s_mov_b32 s81, 1400832
  buffer_load_dwordx4 v82, s[4:7], s81 offen lds
  s_add_u32 m0, s75, 83968
  s_mov_b32 s81, 1425408
  buffer_load_dwordx4 v82, s[4:7], s81 offen lds
  s_add_u32 m0, s75, 84992
  s_mov_b32 s81, 1449984
  buffer_load_dwordx4 v82, s[4:7], s81 offen lds
  s_waitcnt vmcnt(8)
  s_barrier
  s_lshl_b32 s76, s75, 1
  s_add_u32 m0, s76, 98304
  s_mov_b32 s81, 0
  buffer_load_dwordx4 v83, s[4:7], s81 offen lds
  s_add_u32 m0, s76, 99328
  s_mov_b32 s81, 24576
  buffer_load_dwordx4 v83, s[4:7], s81 offen lds
  s_add_u32 m0, s76, 100352
  s_mov_b32 s81, 49152
  buffer_load_dwordx4 v83, s[4:7], s81 offen lds
  s_add_u32 m0, s76, 101376
  s_mov_b32 s81, 73728
  buffer_load_dwordx4 v83, s[4:7], s81 offen lds
  s_add_u32 m0, s76, 102400
  s_mov_b32 s81, 98304
  buffer_load_dwordx4 v83, s[4:7], s81 offen lds
  s_add_u32 m0, s76, 103424
  s_mov_b32 s81, 122880
  buffer_load_dwordx4 v83, s[4:7], s81 offen lds
  s_add_u32 m0, s76, 104448
  s_mov_b32 s81, 147456
  buffer_load_dwordx4 v83, s[4:7], s81 offen lds
  s_add_u32 m0, s76, 105472
  s_mov_b32 s81, 172032
  buffer_load_dwordx4 v83, s[4:7], s81 offen lds
  s_waitcnt vmcnt(8)
  s_barrier
  s_lshl_b32 s76, s75, 1
  s_add_u32 m0, s76, 131072
  s_mov_b32 s81, 786432
  buffer_load_dwordx4 v83, s[4:7], s81 offen lds
  s_add_u32 m0, s76, 132096
  s_mov_b32 s81, 811008
  buffer_load_dwordx4 v83, s[4:7], s81 offen lds
  s_add_u32 m0, s76, 133120
  s_mov_b32 s81, 835584
  buffer_load_dwordx4 v83, s[4:7], s81 offen lds
  s_add_u32 m0, s76, 134144
  s_mov_b32 s81, 860160
  buffer_load_dwordx4 v83, s[4:7], s81 offen lds
  s_add_u32 m0, s76, 135168
  s_mov_b32 s81, 884736
  buffer_load_dwordx4 v83, s[4:7], s81 offen lds
  s_add_u32 m0, s76, 136192
  s_mov_b32 s81, 909312
  buffer_load_dwordx4 v83, s[4:7], s81 offen lds
  s_add_u32 m0, s76, 137216
  s_mov_b32 s81, 933888
  buffer_load_dwordx4 v83, s[4:7], s81 offen lds
  s_add_u32 m0, s76, 138240
  s_mov_b32 s81, 958464
  buffer_load_dwordx4 v83, s[4:7], s81 offen lds
  s_waitcnt vmcnt(8)
  s_mov_b32 s16, s66
  s_mov_b32 s17, s67
  s_mov_b32 s18, 0x100
  s_mov_b32 s19, 0x20000
  buffer_load_dword v6, off, s[16:19], 0 sc1
  s_barrier
  s_lshl_b32 s82, s80, 15
  s_lshl_b32 s83, s95, 8
  s_add_u32 s82, s82, s83
  s_lshl_b32 s83, s80, 13
  s_lshl_b32 s85, s94, 15
  s_lshl_b32 s77, s80, 13
  s_add_u32 s85, s85, s77
  s_add_u32 s86, s85, 4096
  ds_read_b64_tr_b16 v[150:151], v88 offset:0
  ds_read_b64_tr_b16 v[152:153], v89 offset:256
  ds_read_b64_tr_b16 v[154:155], v88 offset:1024
  ds_read_b64_tr_b16 v[156:157], v89 offset:1280
  ds_read_b64_tr_b16 v[158:159], v88 offset:4096
  ds_read_b64_tr_b16 v[160:161], v89 offset:4352
  ds_read_b64_tr_b16 v[162:163], v88 offset:5120
  ds_read_b64_tr_b16 v[164:165], v89 offset:5376
  ds_read_b64_tr_b16 v[166:167], v88 offset:8192
  ds_read_b64_tr_b16 v[168:169], v89 offset:8448
  ds_read_b64_tr_b16 v[170:171], v88 offset:9216
  ds_read_b64_tr_b16 v[172:173], v89 offset:9472
  ds_read_b64_tr_b16 v[174:175], v88 offset:12288
  ds_read_b64_tr_b16 v[176:177], v89 offset:12544
  ds_read_b64_tr_b16 v[178:179], v88 offset:13312
  ds_read_b64_tr_b16 v[180:181], v89 offset:13568
  s_lshl_b32 s76, s88, 12
  s_lshl_b32 s77, s89, 11
  s_add_u32 s76, s76, s77
  v_add_u32 v2, s76, v5
  ds_read_b128 v[16:19], v2 offset:0
  ds_read_b128 v[20:23], v2 offset:1024
  s_waitcnt lgkmcnt(0)
  v_mfma_f32_32x32x16_bf16 v[24:39], v[8:11], v[16:19], 0
  v_mfma_f32_32x32x16_bf16 v[24:39], v[12:15], v[20:23], v[24:39]
  s_nop 11
  v_max3_f32 v56, v24, v25, v26
  buffer_load_dwordx4 v[200:203], v5, s[8:11], s85 offen offset:0
  v_min3_f32 v57, v24, v25, v26
  v_max3_f32 v58, v27, v28, v29
  v_min3_f32 v59, v27, v28, v29
  v_max3_f32 v56, v56, v30, v31
  v_min3_f32 v57, v57, v30, v31
  v_max3_f32 v58, v58, v32, v33
  v_min3_f32 v59, v59, v32, v33
  v_max3_f32 v56, v56, v34, v35
  v_min3_f32 v57, v57, v34, v35
  v_max3_f32 v58, v58, v36, v37
  v_min3_f32 v59, v59, v36, v37
  v_max3_f32 v56, v56, v38, v39
  buffer_load_dwordx4 v[204:207], v5, s[8:11], s85 offen offset:1024
  v_min3_f32 v57, v57, v38, v39
  v_max_f32 v56, v56, v58
  v_min_f32 v57, v57, v59
  v_pk_mul_f32 v[56:57], v[56:57], s[90:91] neg_lo:[0,1]
  v_pk_fma_f32 v[40:41], v[24:25], s[90:91], v[56:57] op_sel:[0,0,1] op_sel_hi:[1,1,1] neg_lo:[1,0,0] neg_hi:[1,0,0]
  v_pk_fma_f32 v[24:25], v[24:25], s[90:91], v[56:57] op_sel:[0,0,0] op_sel_hi:[1,1,0]
  v_pk_fma_f32 v[42:43], v[26:27], s[90:91], v[56:57] op_sel:[0,0,1] op_sel_hi:[1,1,1] neg_lo:[1,0,0] neg_hi:[1,0,0]
  v_pk_fma_f32 v[26:27], v[26:27], s[90:91], v[56:57] op_sel:[0,0,0] op_sel_hi:[1,1,0]
  v_pk_fma_f32 v[44:45], v[28:29], s[90:91], v[56:57] op_sel:[0,0,1] op_sel_hi:[1,1,1] neg_lo:[1,0,0] neg_hi:[1,0,0]
  v_pk_fma_f32 v[28:29], v[28:29], s[90:91], v[56:57] op_sel:[0,0,0] op_sel_hi:[1,1,0]
  v_pk_fma_f32 v[46:47], v[30:31], s[90:91], v[56:57] op_sel:[0,0,1] op_sel_hi:[1,1,1] neg_lo:[1,0,0] neg_hi:[1,0,0]
  v_pk_fma_f32 v[30:31], v[30:31], s[90:91], v[56:57] op_sel:[0,0,0] op_sel_hi:[1,1,0]
  v_pk_fma_f32 v[48:49], v[32:33], s[90:91], v[56:57] op_sel:[0,0,1] op_sel_hi:[1,1,1] neg_lo:[1,0,0] neg_hi:[1,0,0]
  buffer_load_dwordx4 v[208:211], v5, s[8:11], s85 offen offset:2048
  v_pk_fma_f32 v[32:33], v[32:33], s[90:91], v[56:57] op_sel:[0,0,0] op_sel_hi:[1,1,0]
  v_pk_fma_f32 v[50:51], v[34:35], s[90:91], v[56:57] op_sel:[0,0,1] op_sel_hi:[1,1,1] neg_lo:[1,0,0] neg_hi:[1,0,0]
  v_pk_fma_f32 v[34:35], v[34:35], s[90:91], v[56:57] op_sel:[0,0,0] op_sel_hi:[1,1,0]
  v_pk_fma_f32 v[52:53], v[36:37], s[90:91], v[56:57] op_sel:[0,0,1] op_sel_hi:[1,1,1] neg_lo:[1,0,0] neg_hi:[1,0,0]
  v_pk_fma_f32 v[36:37], v[36:37], s[90:91], v[56:57] op_sel:[0,0,0] op_sel_hi:[1,1,0]
  v_pk_fma_f32 v[54:55], v[38:39], s[90:91], v[56:57] op_sel:[0,0,1] op_sel_hi:[1,1,1] neg_lo:[1,0,0] neg_hi:[1,0,0]
  v_pk_fma_f32 v[38:39], v[38:39], s[90:91], v[56:57] op_sel:[0,0,0] op_sel_hi:[1,1,0]
  v_exp_f32 v24, v24
  v_exp_f32 v40, v40
  v_exp_f32 v25, v25
  v_exp_f32 v41, v41
  v_exp_f32 v26, v26
  v_exp_f32 v42, v42
  buffer_load_dwordx4 v[212:215], v5, s[8:11], s85 offen offset:3072
  v_exp_f32 v27, v27
  v_exp_f32 v43, v43
  v_exp_f32 v28, v28
  v_exp_f32 v44, v44
  v_exp_f32 v29, v29
  v_exp_f32 v45, v45
  v_exp_f32 v30, v30
  v_exp_f32 v46, v46
  v_exp_f32 v31, v31
  v_exp_f32 v47, v47
  v_exp_f32 v32, v32
  v_exp_f32 v48, v48
  v_exp_f32 v33, v33
  buffer_load_dwordx4 v[216:219], v5, s[8:11], s86 offen offset:0
  v_exp_f32 v49, v49
  v_exp_f32 v34, v34
  v_exp_f32 v50, v50
  v_exp_f32 v35, v35
  v_exp_f32 v51, v51
  v_exp_f32 v36, v36
  v_exp_f32 v52, v52
  v_exp_f32 v37, v37
  v_exp_f32 v53, v53
  v_exp_f32 v38, v38
  v_exp_f32 v54, v54
  v_exp_f32 v39, v39
  buffer_load_dwordx4 v[220:223], v5, s[8:11], s86 offen offset:1024
  v_exp_f32 v55, v55
  v_pk_add_f32 v[64:65], v[24:25], v[26:27]
  v_pk_add_f32 v[68:69], v[40:41], v[42:43]
  v_pk_add_f32 v[66:67], v[28:29], v[30:31]
  v_pk_add_f32 v[70:71], v[44:45], v[46:47]
  v_pk_add_f32 v[64:65], v[64:65], v[32:33]
  v_pk_add_f32 v[68:69], v[68:69], v[48:49]
  v_pk_add_f32 v[66:67], v[66:67], v[34:35]
  v_pk_add_f32 v[70:71], v[70:71], v[50:51]
  v_pk_add_f32 v[64:65], v[64:65], v[36:37]
  v_pk_add_f32 v[68:69], v[68:69], v[52:53]
  v_pk_add_f32 v[66:67], v[66:67], v[38:39]
  v_pk_add_f32 v[70:71], v[70:71], v[54:55]
  buffer_load_dwordx4 v[224:227], v5, s[8:11], s86 offen offset:2048
  v_pk_add_f32 v[64:65], v[64:65], v[66:67]
  v_pk_add_f32 v[68:69], v[68:69], v[70:71]
  v_add_f32 v60, v64, v65
  v_add_f32 v61, v68, v69
  v_rcp_f32 v60, v60
  v_rcp_f32 v61, v61
  s_nop 0
  v_pk_mul_f32 v[24:25], v[24:25], v[60:61] op_sel:[0,0] op_sel_hi:[1,0]
  v_pk_mul_f32 v[40:41], v[40:41], v[60:61] op_sel:[0,1] op_sel_hi:[1,1]
  v_pk_mul_f32 v[26:27], v[26:27], v[60:61] op_sel:[0,0] op_sel_hi:[1,0]
  v_pk_mul_f32 v[42:43], v[42:43], v[60:61] op_sel:[0,1] op_sel_hi:[1,1]
  v_pk_mul_f32 v[28:29], v[28:29], v[60:61] op_sel:[0,0] op_sel_hi:[1,0]
  v_pk_mul_f32 v[44:45], v[44:45], v[60:61] op_sel:[0,1] op_sel_hi:[1,1]
  v_pk_mul_f32 v[30:31], v[30:31], v[60:61] op_sel:[0,0] op_sel_hi:[1,0]
  buffer_load_dwordx4 v[228:231], v5, s[8:11], s86 offen offset:3072
  v_pk_mul_f32 v[46:47], v[46:47], v[60:61] op_sel:[0,1] op_sel_hi:[1,1]
  v_pk_mul_f32 v[32:33], v[32:33], v[60:61] op_sel:[0,0] op_sel_hi:[1,0]
  v_pk_mul_f32 v[48:49], v[48:49], v[60:61] op_sel:[0,1] op_sel_hi:[1,1]
  v_pk_mul_f32 v[34:35], v[34:35], v[60:61] op_sel:[0,0] op_sel_hi:[1,0]
  v_pk_mul_f32 v[50:51], v[50:51], v[60:61] op_sel:[0,1] op_sel_hi:[1,1]
  v_pk_mul_f32 v[36:37], v[36:37], v[60:61] op_sel:[0,0] op_sel_hi:[1,0]
  v_pk_mul_f32 v[52:53], v[52:53], v[60:61] op_sel:[0,1] op_sel_hi:[1,1]
  v_pk_mul_f32 v[38:39], v[38:39], v[60:61] op_sel:[0,0] op_sel_hi:[1,0]
  v_pk_mul_f32 v[54:55], v[54:55], v[60:61] op_sel:[0,1] op_sel_hi:[1,1]
  v_cvt_pk_bf16_f32 v64, v24, v25
  v_cvt_pk_bf16_f32 v65, v26, v27
  v_cvt_pk_bf16_f32 v66, v28, v29
  v_cvt_pk_bf16_f32 v67, v30, v31
  buffer_load_dwordx4 v[232:235], v5, s[32:35], 0 offen
  v_cvt_pk_bf16_f32 v68, v32, v33
  v_cvt_pk_bf16_f32 v69, v34, v35
  v_cvt_pk_bf16_f32 v70, v36, v37
  v_cvt_pk_bf16_f32 v71, v38, v39
  v_cvt_pk_bf16_f32 v72, v40, v41
  v_cvt_pk_bf16_f32 v73, v42, v43
  v_cvt_pk_bf16_f32 v74, v44, v45
  v_cvt_pk_bf16_f32 v75, v46, v47
  v_cvt_pk_bf16_f32 v76, v48, v49
  v_cvt_pk_bf16_f32 v77, v50, v51
  v_cvt_pk_bf16_f32 v78, v52, v53
  v_cvt_pk_bf16_f32 v79, v54, v55
  ds_write_b128 v7, v[64:67]
  v_xor_b32 v2, 16, v7
  ds_write_b128 v2, v[68:71]
  v_xor_b32 v2, 32, v7
  ds_write_b128 v2, v[72:75]
  v_xor_b32 v2, 48, v7
  ds_write_b128 v2, v[76:79]
  s_waitcnt vmcnt(9)
  s_mov_b32 s77, 0
G_hz_a:
  v_readfirstlane_b32 s76, v6
  s_nop 1
  s_cmp_ge_u32 s76, 8
  s_cbranch_scc1 G_hz_b
  buffer_load_dword v6, off, s[16:19], 0 sc1
  s_add_u32 s77, s77, 1
  s_cmp_ge_u32 s77, 65536
  s_cbranch_scc1 K_end
  s_waitcnt vmcnt(0)
  s_branch G_hz_a
G_hz_b:
  s_lshl_b32 s76, s74, 2
  s_add_u32 s76, s76, s80
  s_lshl_b32 s76, s76, 11
  s_lshr_b32 s77, s76, 4
  s_add_u32 s77, s77, 65536
  s_waitcnt lgkmcnt(0)
  s_barrier
  s_setprio 3
  ds_read_b64_tr_b16 v[118:119], v90 offset:0
  ds_read_b64_tr_b16 v[120:121], v91 offset:256
  ds_read_b64_tr_b16 v[122:123], v90 offset:1024
  ds_read_b64_tr_b16 v[124:125], v91 offset:1280
  ds_read_b64_tr_b16 v[126:127], v90 offset:8192
  ds_read_b64_tr_b16 v[128:129], v91 offset:8448
  ds_read_b64_tr_b16 v[130:131], v90 offset:9216
  ds_read_b64_tr_b16 v[132:133], v91 offset:9472
  ds_read_b64_tr_b16 v[134:135], v90 offset:16384
  ds_read_b64_tr_b16 v[136:137], v91 offset:16640
  ds_read_b64_tr_b16 v[138:139], v90 offset:17408
  ds_read_b64_tr_b16 v[140:141], v91 offset:17664
  ds_read_b64_tr_b16 v[142:143], v90 offset:24576
  ds_read_b64_tr_b16 v[144:145], v91 offset:24832
  ds_read_b64_tr_b16 v[146:147], v90 offset:25600
  ds_read_b64_tr_b16 v[148:149], v91 offset:25856
  v_and_or_b32 v150, v150, v85, v86
  v_and_or_b32 v151, v151, v85, v86
  v_and_or_b32 v152, v152, v85, v86
  v_and_or_b32 v153, v153, v85, v86
  s_waitcnt lgkmcnt(14)
  s_nop 0
  v_mfma_f32_32x32x16_bf16 v[102:117], v[150:153], v[118:121], 0
  v_and_or_b32 v154, v154, v85, v86
  v_and_or_b32 v155, v155, v85, v86
  v_and_or_b32 v156, v156, v85, v86
  v_and_or_b32 v157, v157, v85, v86
  s_waitcnt lgkmcnt(12)
  s_nop 0
  v_mfma_f32_32x32x16_bf16 v[102:117], v[154:157], v[122:125], v[102:117]
  v_and_or_b32 v158, v158, v85, v86
  v_and_or_b32 v159, v159, v85, v86
  v_and_or_b32 v160, v160, v85, v86
  v_and_or_b32 v161, v161, v85, v86
  s_waitcnt lgkmcnt(10)
  s_nop 0
  v_mfma_f32_32x32x16_bf16 v[102:117], v[158:161], v[126:129], v[102:117]
  v_and_or_b32 v162, v162, v85, v86
  v_and_or_b32 v163, v163, v85, v86
  v_and_or_b32 v164, v164, v85, v86
  v_and_or_b32 v165, v165, v85, v86
  s_waitcnt lgkmcnt(8)
  s_nop 0
  v_mfma_f32_32x32x16_bf16 v[102:117], v[162:165], v[130:133], v[102:117]
  v_and_or_b32 v166, v166, v85, v86
  v_and_or_b32 v167, v167, v85, v86
  v_and_or_b32 v168, v168, v85, v86
  v_and_or_b32 v169, v169, v85, v86
  s_waitcnt lgkmcnt(6)
  s_nop 0
  v_mfma_f32_32x32x16_bf16 v[102:117], v[166:169], v[134:137], v[102:117]
  v_and_or_b32 v170, v170, v85, v86
  v_and_or_b32 v171, v171, v85, v86
  v_and_or_b32 v172, v172, v85, v86
  v_and_or_b32 v173, v173, v85, v86
  s_waitcnt lgkmcnt(4)
  s_nop 0
  v_mfma_f32_32x32x16_bf16 v[102:117], v[170:173], v[138:141], v[102:117]
  v_and_or_b32 v174, v174, v85, v86
  v_and_or_b32 v175, v175, v85, v86
  v_and_or_b32 v176, v176, v85, v86
  v_and_or_b32 v177, v177, v85, v86
  s_waitcnt lgkmcnt(2)
  s_nop 0
  v_mfma_f32_32x32x16_bf16 v[102:117], v[174:177], v[142:145], v[102:117]
  v_and_or_b32 v178, v178, v85, v86
  v_and_or_b32 v179, v179, v85, v86
  v_and_or_b32 v180, v180, v85, v86
  v_and_or_b32 v181, v181, v85, v86
  s_waitcnt lgkmcnt(0)
  s_nop 0
  v_mfma_f32_32x32x16_bf16 v[102:117], v[178:181], v[146:149], v[102:117]
  s_nop 11
  buffer_atomic_add_f32 v102, v92, s[24:27], s76 offen offset:0
  buffer_atomic_add_f32 v103, v92, s[24:27], s76 offen offset:128
  buffer_atomic_add_f32 v104, v92, s[24:27], s76 offen offset:256
  buffer_atomic_add_f32 v105, v92, s[24:27], s76 offen offset:384
  buffer_atomic_add_f32 v106, v92, s[24:27], s76 offen offset:1024
  buffer_atomic_add_f32 v107, v92, s[24:27], s76 offen offset:1152
  buffer_atomic_add_f32 v108, v92, s[24:27], s76 offen offset:1280
  buffer_atomic_add_f32 v109, v92, s[24:27], s76 offen offset:1408
  s_mov_b32 exec_hi, 0
  buffer_atomic_add_f32 v110, v93, s[24:27], s77 offen
  s_mov_b64 exec, -1
  s_setprio 0
  s_barrier
  s_lshl_b32 s93, s80, 5
  s_lshl_b32 s87, s74, 4
  s_add_u32 s87, s87, s73
  s_lshl_b32 s87, s87, 5
  s_add_u32 s87, s87, s80
  s_lshl_b32 s87, s87, 2
  s_add_u32 s87, s87, 69632
  s_lshl_b32 s76, s80, 11
  v_add_u32 v2, s76, v5
  s_waitcnt vmcnt(0)
  v_mov_b32 v4, 1
  s_mov_b64 exec, 1
  buffer_store_dword v4, off, s[24:27], s87 sc1
  s_mov_b64 exec, -1
  s_add_u32 m0, s83, 32768
  s_add_u32 s84, s82, 393216
  buffer_load_dwordx4 v84, s[28:31], s84 offen lds
  s_add_u32 m0, s83, 33792
  s_add_u32 s84, s82, 397312
  buffer_load_dwordx4 v84, s[28:31], s84 offen lds
  s_add_u32 m0, s83, 34816
  s_add_u32 s84, s82, 401408
  buffer_load_dwordx4 v84, s[28:31], s84 offen lds
  s_add_u32 m0, s83, 35840
  s_add_u32 s84, s82, 405504
  buffer_load_dwordx4 v84, s[28:31], s84 offen lds
  s_add_u32 m0, s83, 36864
  s_add_u32 s84, s82, 409600
  buffer_load_dwordx4 v84, s[28:31], s84 offen lds
  s_add_u32 m0, s83, 37888
  s_add_u32 s84, s82, 413696
  buffer_load_dwordx4 v84, s[28:31], s84 offen lds
  s_add_u32 m0, s83, 38912
  s_add_u32 s84, s82, 417792
  buffer_load_dwordx4 v84, s[28:31], s84 offen lds
  s_add_u32 m0, s83, 39936
  s_add_u32 s84, s82, 421888
  buffer_load_dwordx4 v84, s[28:31], s84 offen lds
  s_cmp_eq_u32 s80, 0
  s_cbranch_scc1 G_nop2
  s_add_u32 m0, s83, 0
  s_add_u32 s84, s82, 262144
  buffer_load_dwordx4 v84, s[28:31], s84 offen lds
  s_add_u32 m0, s83, 1024
  s_add_u32 s84, s82, 266240
  buffer_load_dwordx4 v84, s[28:31], s84 offen lds
  s_add_u32 m0, s83, 2048
  s_add_u32 s84, s82, 270336
  buffer_load_dwordx4 v84, s[28:31], s84 offen lds
  s_add_u32 m0, s83, 3072
  s_add_u32 s84, s82, 274432
  buffer_load_dwordx4 v84, s[28:31], s84 offen lds
  s_add_u32 m0, s83, 4096
  s_add_u32 s84, s82, 278528
  buffer_load_dwordx4 v84, s[28:31], s84 offen lds
  s_add_u32 m0, s83, 5120
  s_add_u32 s84, s82, 282624
  buffer_load_dwordx4 v84, s[28:31], s84 offen lds
  s_add_u32 m0, s83, 6144
  s_add_u32 s84, s82, 286720
  buffer_load_dwordx4 v84, s[28:31], s84 offen lds
  s_add_u32 m0, s83, 7168
  s_add_u32 s84, s82, 290816
  buffer_load_dwordx4 v84, s[28:31], s84 offen lds
G_nop2:
  s_mov_b32 s70, 65536
  s_mov_b32 s71, 131072
  s_mov_b32 s92, 2
  s_lshl_b32 s86, s74, 11
  s_add_u32 s86, s86, 69632
  v_lshlrev_b32 v80, 7, v1
  s_lshl_b32 s83, s74, 1
  s_add_u32 s83, s83, s89
  s_lshl_b32 s82, s83, 12
  v_and_b32 v7, 31, v1
  v_lshlrev_b32 v7, 4, v7
  v_lshl_add_u32 v7, v3, 10, v7
  s_lshl_b32 s84, s73, 2
  s_add_u32 s84, s84, s88
  s_lshl_b32 s84, s84, 15
  s_lshl_b32 s75, s83, 11
  s_add_u32 s84, s84, s75
  s_lshl_b32 s83, s83, 8
  s_add_u32 s83, s83, 65536
  s_lshl_b32 s75, s72, 12
  s_add_u32 s75, s75, 131072
  v_lshl_add_u32 v86, v1, 3, s75
  v_bfe_u32 v252, v1, 2, 1
  v_lshlrev_b32 v87, 10, v252
  v_xor_b32 v88, v252, v3
  v_and_b32 v252, 3, v1
  v_lshl_add_u32 v87, v252, 6, v87
  v_bfe_u32 v252, v1, 3, 2
  v_lshl_add_u32 v87, v252, 8, v87
  v_add_u32 v88, -1, v88
  v_mov_b32 v252, 2560
  v_bfi_b32 v87, v88, v87, v252
  v_add_u32 v87, s75, v87
  v_lshl_add_u32 v88, v3, 6, s75
  v_mov_b32 v252, 0
  v_mov_b32 v253, 0
  s_lshl_b32 s3, s73, 3
  s_add_u32 s3, s3, s74
  s_lshl_b32 s3, s3, 7
  s_add_u32 s3, s3, 86016
  s_barrier
  ds_read_b128 v[16:19], v2 offset:0
  ds_read_b128 v[20:23], v2 offset:1024
  s_lshl_b32 s76, s80, 13
  s_lshl_b32 s77, s95, 8
  s_add_u32 s76, s76, s77
  s_lshl_b32 s77, s80, 11
  s_waitcnt lgkmcnt(0)
  s_add_u32 m0, s77, 0
  s_add_u32 s78, s76, 262144
  buffer_load_dwordx4 v84, s[28:31], s78 offen lds
  s_add_u32 m0, s77, 1024
  s_add_u32 s78, s76, 266240
  buffer_load_dwordx4 v84, s[28:31], s78 offen lds
  s_branch G_epi
G_compute:
  s_and_b32 s88, s72, 1
  s_lshl_b32 s88, s88, 1
  s_lshr_b32 s76, s80, 1
  s_add_u32 s88, s88, s76
  s_lshr_b32 s89, s72, 2
  s_mov_b32 s12, s40
  s_mov_b32 s13, s41
  s_mov_b32 s14, 0x4000
  s_mov_b32 s15, 0x20000
  s_lshl_b32 s76, s74, 11
  s_lshl_b32 s77, s89, 10
  s_add_u32 s76, s76, s77
  buffer_load_dwordx4 v[86:89], v5, s[12:15], s76 offen
  s_add_u32 s24, s68, 0x600000
  s_addc_u32 s25, s69, 0
  s_mov_b32 s26, 0x1b000
  s_mov_b32 s27, 0x20000
  s_mov_b32 s20, s68
  s_mov_b32 s21, s69
  s_mov_b32 s22, 0x400000
  s_mov_b32 s23, 0x20000
  s_mov_b32 s90, 0x3fb8aa3b
  s_mov_b32 s91, 0x3fb8aa3b
  v_and_b32 v4, 31, v1
  v_lshlrev_b32 v7, 6, v4
  v_bfe_u32 v4, v1, 1, 2
  v_lshl_add_u32 v7, v4, 4, v7
  v_lshrrev_b32 v4, 5, v1
  v_lshl_add_u32 v7, v4, 11, v7
  s_lshl_b32 s76, s88, 13
  s_lshl_b32 s77, s89, 12
  s_add_u32 s76, s76, s77
  s_add_u32 s76, s76, 32768
  v_add_u32 v7, s76, v7
  s_mov_b32 s93, -1
  v_and_b32 v2, 31, v1
  v_lshrrev_b32 v3, 5, v1
  v_bfe_u32 v4, v1, 1, 3
  v_xor_b32 v4, v4, v3
  s_lshl_b32 s76, s88, 12
  v_lshlrev_b32 v2, 7, v2
  v_add_u32 v2, s76, v2
  v_lshl_add_u32 v80, v4, 4, v2
  v_bfe_u32 v2, v1, 2, 2
  v_lshl_add_u32 v2, v3, 3, v2
  v_lshlrev_b32 v81, 7, v2
  v_bfe_u32 v2, v1, 4, 1
  v_lshl_add_u32 v81, v2, 5, v81
  v_bfe_u32 v2, v1, 3, 1
  v_lshl_add_u32 v81, v2, 6, v81
  v_and_b32 v2, 3, v1
  v_lshl_add_u32 v81, v2, 3, v81
  s_lshr_b32 s85, s72, 1
  s_lshl_b32 s85, s85, 13
  s_waitcnt vmcnt(0)
  s_lshl_b32 s79, s72, 10
  s_add_u32 s79, s79, 131072
  v_add_u32 v2, s79, v5
  ds_write_b128 v2, v[86:89]
  v_bfe_u32 v2, v1, 2, 2
  v_lshrrev_b32 v4, 5, v1
  v_lshl_add_u32 v2, v4, 2, v2
  v_lshlrev_b32 v2, 5, v2
  v_and_b32 v4, 1, v1
  v_lshl_add_u32 v2, v4, 9, v2
  v_bfe_u32 v4, v1, 1, 1
  v_lshl_add_u32 v2, v4, 3, v2
  v_bfe_u32 v4, v1, 4, 1
  v_lshl_add_u32 v2, v4, 4, v2
  v_add_u32 v2, s79, v2
  ds_read_b64_tr_b16 v[86:87], v2 offset:0
  ds_read_b64_tr_b16 v[88:89], v2 offset:256
  s_waitcnt lgkmcnt(0)
  v_bfe_i32 v2, v1, 2, 1
  v_and_b32 v12, v2, v86
  v_and_b32 v13, v2, v87
  v_and_b32 v14, v2, v88
  v_and_b32 v15, v2, v89
  v_xor_b32 v8, v12, v86
  v_xor_b32 v9, v13, v87
  v_xor_b32 v10, v14, v88
  v_xor_b32 v11, v15, v89
  s_barrier
  s_add_u32 s76, s85, 0
  v_add_u32 v84, s76, v81
  v_xor_b32 v85, 64, v84
  ds_read_b64_tr_b16 v[218:219], v84 offset:16384
  ds_read_b64_tr_b16 v[220:221], v84 offset:16896
  v_xor_b32 v82, 0x0, v80
  ds_read_b128 v[90:93], v82 offset:0
  ds_read_b64_tr_b16 v[222:223], v85 offset:16384
  ds_read_b64_tr_b16 v[224:225], v85 offset:16896
  v_xor_b32 v83, 0x1000, v80
  ds_read_b128 v[226:229], v83 offset:0
  ds_read_b64_tr_b16 v[230:231], v84 offset:18432
  ds_read_b64_tr_b16 v[232:233], v84 offset:18944
  v_xor_b32 v82, 0x20, v80
  ds_read_b128 v[94:97], v82 offset:0
  ds_read_b64_tr_b16 v[234:235], v85 offset:18432
  ds_read_b64_tr_b16 v[236:237], v85 offset:18944
  v_xor_b32 v83, 0x1020, v80
  ds_read_b128 v[238:241], v83 offset:0
  s_waitcnt lgkmcnt(6)
  v_mfma_f32_32x32x16_bf16 v[16:31], v[218:221], v[90:93], 0
  ds_read_b64_tr_b16 v[242:243], v84 offset:20480
  ds_read_b64_tr_b16 v[244:245], v84 offset:20992
  v_mfma_f32_32x32x16_bf16 v[32:47], v[222:225], v[90:93], 0
  v_xor_b32 v82, 0x40, v80
  ds_read_b128 v[98:101], v82 offset:0
  v_mfma_f32_32x32x16_bf16 v[48:63], v[218:221], v[226:229], 0
  ds_read_b64_tr_b16 v[246:247], v85 offset:20480
  ds_read_b64_tr_b16 v[248:249], v85 offset:20992
  v_mfma_f32_32x32x16_bf16 v[64:79], v[222:225], v[226:229], 0
  v_xor_b32 v83, 0x1040, v80
  ds_read_b128 v[250:253], v83 offset:0
  s_waitcnt lgkmcnt(6)
  v_mfma_f32_32x32x16_bf16 v[16:31], v[230:233], v[94:97], v[16:31]
  ds_read_b64_tr_b16 v[218:219], v84 offset:22528
  ds_read_b64_tr_b16 v[220:221], v84 offset:23040
  v_mfma_f32_32x32x16_bf16 v[32:47], v[234:237], v[94:97], v[32:47]
  v_xor_b32 v82, 0x60, v80
  ds_read_b128 v[102:105], v82 offset:0
  v_mfma_f32_32x32x16_bf16 v[48:63], v[230:233], v[238:241], v[48:63]
  ds_read_b64_tr_b16 v[222:223], v85 offset:22528
  ds_read_b64_tr_b16 v[224:225], v85 offset:23040
  v_mfma_f32_32x32x16_bf16 v[64:79], v[234:237], v[238:241], v[64:79]
  v_xor_b32 v83, 0x1060, v80
  ds_read_b128 v[226:229], v83 offset:0
  s_waitcnt lgkmcnt(6)
  v_mfma_f32_32x32x16_bf16 v[16:31], v[242:245], v[98:101], v[16:31]
  s_barrier
  s_add_u32 s76, s85, 0
  v_add_u32 v84, s76, v81
  v_xor_b32 v85, 64, v84
  v_mfma_f32_32x32x16_bf16 v[32:47], v[246:249], v[98:101], v[32:47]
  ds_read_b64_tr_b16 v[230:231], v84 offset:49152
  ds_read_b64_tr_b16 v[232:233], v84 offset:49664
  v_mfma_f32_32x32x16_bf16 v[48:63], v[242:245], v[250:253], v[48:63]
  v_xor_b32 v82, 0x0, v80
  ds_read_b128 v[106:109], v82 offset:32768
  ds_read_b64_tr_b16 v[234:235], v85 offset:49152
  v_mfma_f32_32x32x16_bf16 v[64:79], v[246:249], v[250:253], v[64:79]
  ds_read_b64_tr_b16 v[236:237], v85 offset:49664
  v_xor_b32 v83, 0x1000, v80
  ds_read_b128 v[238:241], v83 offset:32768
  s_waitcnt lgkmcnt(6)
  v_mfma_f32_32x32x16_bf16 v[16:31], v[218:221], v[102:105], v[16:31]
  ds_read_b64_tr_b16 v[242:243], v84 offset:51200
  ds_read_b64_tr_b16 v[244:245], v84 offset:51712
  v_mfma_f32_32x32x16_bf16 v[32:47], v[222:225], v[102:105], v[32:47]
  v_xor_b32 v82, 0x20, v80
  ds_read_b128 v[110:113], v82 offset:32768
  v_mfma_f32_32x32x16_bf16 v[48:63], v[218:221], v[226:229], v[48:63]
  ds_read_b64_tr_b16 v[246:247], v85 offset:51200
  ds_read_b64_tr_b16 v[248:249], v85 offset:51712
  v_mfma_f32_32x32x16_bf16 v[64:79], v[222:225], v[226:229], v[64:79]
  v_xor_b32 v83, 0x1020, v80
  ds_read_b128 v[250:253], v83 offset:32768
  s_waitcnt lgkmcnt(6)
  v_mfma_f32_32x32x16_bf16 v[16:31], v[230:233], v[106:109], v[16:31]
  ds_read_b64_tr_b16 v[218:219], v84 offset:53248
  ds_read_b64_tr_b16 v[220:221], v84 offset:53760
  v_mfma_f32_32x32x16_bf16 v[32:47], v[234:237], v[106:109], v[32:47]
  v_xor_b32 v82, 0x40, v80
  ds_read_b128 v[114:117], v82 offset:32768
  v_mfma_f32_32x32x16_bf16 v[48:63], v[230:233], v[238:241], v[48:63]
  ds_read_b64_tr_b16 v[222:223], v85 offset:53248
  ds_read_b64_tr_b16 v[224:225], v85 offset:53760
  v_mfma_f32_32x32x16_bf16 v[64:79], v[234:237], v[238:241], v[64:79]
  v_xor_b32 v83, 0x1040, v80
  ds_read_b128 v[226:229], v83 offset:32768
  s_waitcnt lgkmcnt(6)
  v_mfma_f32_32x32x16_bf16 v[16:31], v[242:245], v[110:113], v[16:31]
  ds_read_b64_tr_b16 v[230:231], v84 offset:55296
  ds_read_b64_tr_b16 v[232:233], v84 offset:55808
  v_mfma_f32_32x32x16_bf16 v[32:47], v[246:249], v[110:113], v[32:47]
  v_xor_b32 v82, 0x60, v80
  ds_read_b128 v[118:121], v82 offset:32768
  v_mfma_f32_32x32x16_bf16 v[48:63], v[242:245], v[250:253], v[48:63]
  ds_read_b64_tr_b16 v[234:235], v85 offset:55296
  ds_read_b64_tr_b16 v[236:237], v85 offset:55808
  v_mfma_f32_32x32x16_bf16 v[64:79], v[246:249], v[250:253], v[64:79]
  v_xor_b32 v83, 0x1060, v80
  ds_read_b128 v[238:241], v83 offset:32768
  s_waitcnt lgkmcnt(6)
  v_mfma_f32_32x32x16_bf16 v[16:31], v[218:221], v[114:117], v[16:31]
  s_barrier
  s_add_u32 s76, s85, 65536
  v_add_u32 v84, s76, v81
  v_xor_b32 v85, 64, v84
  v_mfma_f32_32x32x16_bf16 v[32:47], v[222:225], v[114:117], v[32:47]
  ds_read_b64_tr_b16 v[242:243], v84 offset:16384
  ds_read_b64_tr_b16 v[244:245], v84 offset:16896
  v_mfma_f32_32x32x16_bf16 v[48:63], v[218:221], v[226:229], v[48:63]
  v_xor_b32 v82, 0x10000, v80
  ds_read_b128 v[122:125], v82 offset:0
  ds_read_b64_tr_b16 v[246:247], v85 offset:16384
  v_mfma_f32_32x32x16_bf16 v[64:79], v[222:225], v[226:229], v[64:79]
  ds_read_b64_tr_b16 v[248:249], v85 offset:16896
  v_xor_b32 v83, 0x11000, v80
  ds_read_b128 v[250:253], v83 offset:0
  s_waitcnt lgkmcnt(6)
  v_mfma_f32_32x32x16_bf16 v[16:31], v[230:233], v[118:121], v[16:31]
  ds_read_b64_tr_b16 v[218:219], v84 offset:18432
  ds_read_b64_tr_b16 v[220:221], v84 offset:18944
  v_mfma_f32_32x32x16_bf16 v[32:47], v[234:237], v[118:121], v[32:47]
  v_xor_b32 v82, 0x10020, v80
  ds_read_b128 v[126:129], v82 offset:0
  v_mfma_f32_32x32x16_bf16 v[48:63], v[230:233], v[238:241], v[48:63]
  ds_read_b64_tr_b16 v[222:223], v85 offset:18432
  ds_read_b64_tr_b16 v[224:225], v85 offset:18944
  v_mfma_f32_32x32x16_bf16 v[64:79], v[234:237], v[238:241], v[64:79]
  v_xor_b32 v83, 0x11020, v80
  ds_read_b128 v[226:229], v83 offset:0
  s_waitcnt lgkmcnt(6)
  v_mfma_f32_32x32x16_bf16 v[16:31], v[242:245], v[122:125], v[16:31]
  ds_read_b64_tr_b16 v[230:231], v84 offset:20480
  ds_read_b64_tr_b16 v[232:233], v84 offset:20992
  v_mfma_f32_32x32x16_bf16 v[32:47], v[246:249], v[122:125], v[32:47]
  v_xor_b32 v82, 0x10040, v80
  ds_read_b128 v[130:133], v82 offset:0
  v_mfma_f32_32x32x16_bf16 v[48:63], v[242:245], v[250:253], v[48:63]
  ds_read_b64_tr_b16 v[234:235], v85 offset:20480
  ds_read_b64_tr_b16 v[236:237], v85 offset:20992
  v_mfma_f32_32x32x16_bf16 v[64:79], v[246:249], v[250:253], v[64:79]
  v_xor_b32 v83, 0x11040, v80
  ds_read_b128 v[238:241], v83 offset:0
  s_waitcnt lgkmcnt(6)
  v_mfma_f32_32x32x16_bf16 v[16:31], v[218:221], v[126:129], v[16:31]
  ds_read_b64_tr_b16 v[242:243], v84 offset:22528
  ds_read_b64_tr_b16 v[244:245], v84 offset:23040
  v_mfma_f32_32x32x16_bf16 v[32:47], v[222:225], v[126:129], v[32:47]
  v_xor_b32 v82, 0x10060, v80
  ds_read_b128 v[134:137], v82 offset:0
  v_mfma_f32_32x32x16_bf16 v[48:63], v[218:221], v[226:229], v[48:63]
  ds_read_b64_tr_b16 v[246:247], v85 offset:22528
  ds_read_b64_tr_b16 v[248:249], v85 offset:23040
  v_mfma_f32_32x32x16_bf16 v[64:79], v[222:225], v[226:229], v[64:79]
  v_xor_b32 v83, 0x11060, v80
  ds_read_b128 v[250:253], v83 offset:0
  s_waitcnt lgkmcnt(6)
  v_mfma_f32_32x32x16_bf16 v[16:31], v[230:233], v[130:133], v[16:31]
  s_barrier
  s_add_u32 s76, s85, 65536
  v_add_u32 v84, s76, v81
  v_xor_b32 v85, 64, v84
  v_mfma_f32_32x32x16_bf16 v[32:47], v[234:237], v[130:133], v[32:47]
  ds_read_b64_tr_b16 v[218:219], v84 offset:49152
  ds_read_b64_tr_b16 v[220:221], v84 offset:49664
  v_mfma_f32_32x32x16_bf16 v[48:63], v[230:233], v[238:241], v[48:63]
  v_xor_b32 v82, 0x10000, v80
  ds_read_b128 v[138:141], v82 offset:32768
  ds_read_b64_tr_b16 v[222:223], v85 offset:49152
  v_mfma_f32_32x32x16_bf16 v[64:79], v[234:237], v[238:241], v[64:79]
  ds_read_b64_tr_b16 v[224:225], v85 offset:49664
  v_xor_b32 v83, 0x11000, v80
  ds_read_b128 v[226:229], v83 offset:32768
  s_waitcnt lgkmcnt(6)
  v_mfma_f32_32x32x16_bf16 v[16:31], v[242:245], v[134:137], v[16:31]
  ds_read_b64_tr_b16 v[230:231], v84 offset:51200
  ds_read_b64_tr_b16 v[232:233], v84 offset:51712
  v_mfma_f32_32x32x16_bf16 v[32:47], v[246:249], v[134:137], v[32:47]
  v_xor_b32 v82, 0x10020, v80
  ds_read_b128 v[142:145], v82 offset:32768
  v_mfma_f32_32x32x16_bf16 v[48:63], v[242:245], v[250:253], v[48:63]
  ds_read_b64_tr_b16 v[234:235], v85 offset:51200
  ds_read_b64_tr_b16 v[236:237], v85 offset:51712
  v_mfma_f32_32x32x16_bf16 v[64:79], v[246:249], v[250:253], v[64:79]
  v_xor_b32 v83, 0x11020, v80
  ds_read_b128 v[238:241], v83 offset:32768
  s_waitcnt lgkmcnt(6)
  v_mfma_f32_32x32x16_bf16 v[16:31], v[218:221], v[138:141], v[16:31]
  ds_read_b64_tr_b16 v[242:243], v84 offset:53248
  ds_read_b64_tr_b16 v[244:245], v84 offset:53760
  v_mfma_f32_32x32x16_bf16 v[32:47], v[222:225], v[138:141], v[32:47]
  v_xor_b32 v82, 0x10040, v80
  ds_read_b128 v[146:149], v82 offset:32768
  v_mfma_f32_32x32x16_bf16 v[48:63], v[218:221], v[226:229], v[48:63]
  ds_read_b64_tr_b16 v[246:247], v85 offset:53248
  ds_read_b64_tr_b16 v[248:249], v85 offset:53760
  v_mfma_f32_32x32x16_bf16 v[64:79], v[222:225], v[226:229], v[64:79]
  v_xor_b32 v83, 0x11040, v80
  ds_read_b128 v[250:253], v83 offset:32768
  s_waitcnt lgkmcnt(6)
  v_mfma_f32_32x32x16_bf16 v[16:31], v[230:233], v[142:145], v[16:31]
  ds_read_b64_tr_b16 v[218:219], v84 offset:55296
  ds_read_b64_tr_b16 v[220:221], v84 offset:55808
  v_mfma_f32_32x32x16_bf16 v[32:47], v[234:237], v[142:145], v[32:47]
  v_xor_b32 v82, 0x10060, v80
  ds_read_b128 v[150:153], v82 offset:32768
  v_mfma_f32_32x32x16_bf16 v[48:63], v[230:233], v[238:241], v[48:63]
  ds_read_b64_tr_b16 v[222:223], v85 offset:55296
  ds_read_b64_tr_b16 v[224:225], v85 offset:55808
  v_mfma_f32_32x32x16_bf16 v[64:79], v[234:237], v[238:241], v[64:79]
  v_xor_b32 v83, 0x11060, v80
  ds_read_b128 v[226:229], v83 offset:32768
  s_waitcnt lgkmcnt(6)
  v_mfma_f32_32x32x16_bf16 v[16:31], v[242:245], v[146:149], v[16:31]
  s_barrier
  s_add_u32 s76, s85, 131072
  v_add_u32 v84, s76, v81
  v_xor_b32 v85, 64, v84
  v_mfma_f32_32x32x16_bf16 v[32:47], v[246:249], v[146:149], v[32:47]
  ds_read_b64_tr_b16 v[230:231], v84 offset:16384
  ds_read_b64_tr_b16 v[232:233], v84 offset:16896
  v_mfma_f32_32x32x16_bf16 v[48:63], v[242:245], v[250:253], v[48:63]
  v_xor_b32 v82, 0x20000, v80
  ds_read_b128 v[154:157], v82 offset:0
  ds_read_b64_tr_b16 v[234:235], v85 offset:16384
  v_mfma_f32_32x32x16_bf16 v[64:79], v[246:249], v[250:253], v[64:79]
  ds_read_b64_tr_b16 v[236:237], v85 offset:16896
  v_xor_b32 v83, 0x21000, v80
  ds_read_b128 v[238:241], v83 offset:0
  s_waitcnt lgkmcnt(6)
  v_mfma_f32_32x32x16_bf16 v[16:31], v[218:221], v[150:153], v[16:31]
  ds_read_b64_tr_b16 v[242:243], v84 offset:18432
  ds_read_b64_tr_b16 v[244:245], v84 offset:18944
  v_mfma_f32_32x32x16_bf16 v[32:47], v[222:225], v[150:153], v[32:47]
  v_xor_b32 v82, 0x20020, v80
  ds_read_b128 v[158:161], v82 offset:0
  v_mfma_f32_32x32x16_bf16 v[48:63], v[218:221], v[226:229], v[48:63]
  ds_read_b64_tr_b16 v[246:247], v85 offset:18432
  ds_read_b64_tr_b16 v[248:249], v85 offset:18944
  v_mfma_f32_32x32x16_bf16 v[64:79], v[222:225], v[226:229], v[64:79]
  v_xor_b32 v83, 0x21020, v80
  ds_read_b128 v[250:253], v83 offset:0
  s_waitcnt lgkmcnt(6)
  v_mfma_f32_32x32x16_bf16 v[16:31], v[230:233], v[154:157], v[16:31]
  ds_read_b64_tr_b16 v[218:219], v84 offset:20480
  ds_read_b64_tr_b16 v[220:221], v84 offset:20992
  v_mfma_f32_32x32x16_bf16 v[32:47], v[234:237], v[154:157], v[32:47]
  v_xor_b32 v82, 0x20040, v80
  ds_read_b128 v[162:165], v82 offset:0
  v_mfma_f32_32x32x16_bf16 v[48:63], v[230:233], v[238:241], v[48:63]
  ds_read_b64_tr_b16 v[222:223], v85 offset:20480
  ds_read_b64_tr_b16 v[224:225], v85 offset:20992
  v_mfma_f32_32x32x16_bf16 v[64:79], v[234:237], v[238:241], v[64:79]
  v_xor_b32 v83, 0x21040, v80
  ds_read_b128 v[226:229], v83 offset:0
  s_waitcnt lgkmcnt(6)
  v_mfma_f32_32x32x16_bf16 v[16:31], v[242:245], v[158:161], v[16:31]
  ds_read_b64_tr_b16 v[230:231], v84 offset:22528
  ds_read_b64_tr_b16 v[232:233], v84 offset:23040
  v_mfma_f32_32x32x16_bf16 v[32:47], v[246:249], v[158:161], v[32:47]
  v_xor_b32 v82, 0x20060, v80
  ds_read_b128 v[166:169], v82 offset:0
  v_mfma_f32_32x32x16_bf16 v[48:63], v[242:245], v[250:253], v[48:63]
  ds_read_b64_tr_b16 v[234:235], v85 offset:22528
  ds_read_b64_tr_b16 v[236:237], v85 offset:23040
  v_mfma_f32_32x32x16_bf16 v[64:79], v[246:249], v[250:253], v[64:79]
  v_xor_b32 v83, 0x21060, v80
  ds_read_b128 v[238:241], v83 offset:0
  s_waitcnt lgkmcnt(6)
  v_mfma_f32_32x32x16_bf16 v[16:31], v[218:221], v[162:165], v[16:31]
  s_barrier
  s_add_u32 s76, s85, 0
  v_add_u32 v84, s76, v81
  v_xor_b32 v85, 64, v84
  v_mfma_f32_32x32x16_bf16 v[32:47], v[222:225], v[162:165], v[32:47]
  ds_read_b64_tr_b16 v[242:243], v84 offset:16384
  ds_read_b64_tr_b16 v[244:245], v84 offset:16896
  v_mfma_f32_32x32x16_bf16 v[48:63], v[218:221], v[226:229], v[48:63]
  v_xor_b32 v82, 0x0, v80
  ds_read_b128 v[170:173], v82 offset:0
  ds_read_b64_tr_b16 v[246:247], v85 offset:16384
  v_mfma_f32_32x32x16_bf16 v[64:79], v[222:225], v[226:229], v[64:79]
  ds_read_b64_tr_b16 v[248:249], v85 offset:16896
  v_xor_b32 v83, 0x1000, v80
  ds_read_b128 v[250:253], v83 offset:0
  s_waitcnt lgkmcnt(6)
  v_mfma_f32_32x32x16_bf16 v[16:31], v[230:233], v[166:169], v[16:31]
  ds_read_b64_tr_b16 v[218:219], v84 offset:18432
  ds_read_b64_tr_b16 v[220:221], v84 offset:18944
  v_mfma_f32_32x32x16_bf16 v[32:47], v[234:237], v[166:169], v[32:47]
  v_xor_b32 v82, 0x20, v80
  ds_read_b128 v[174:177], v82 offset:0
  v_mfma_f32_32x32x16_bf16 v[48:63], v[230:233], v[238:241], v[48:63]
  ds_read_b64_tr_b16 v[222:223], v85 offset:18432
  ds_read_b64_tr_b16 v[224:225], v85 offset:18944
  v_mfma_f32_32x32x16_bf16 v[64:79], v[234:237], v[238:241], v[64:79]
  v_xor_b32 v83, 0x1020, v80
  ds_read_b128 v[226:229], v83 offset:0
  s_waitcnt lgkmcnt(6)
  v_mfma_f32_32x32x16_bf16 v[16:31], v[242:245], v[170:173], v[16:31]
  ds_read_b64_tr_b16 v[230:231], v84 offset:20480
  ds_read_b64_tr_b16 v[232:233], v84 offset:20992
  v_mfma_f32_32x32x16_bf16 v[32:47], v[246:249], v[170:173], v[32:47]
  v_xor_b32 v82, 0x40, v80
  ds_read_b128 v[178:181], v82 offset:0
  v_mfma_f32_32x32x16_bf16 v[48:63], v[242:245], v[250:253], v[48:63]
  ds_read_b64_tr_b16 v[234:235], v85 offset:20480
  ds_read_b64_tr_b16 v[236:237], v85 offset:20992
  v_mfma_f32_32x32x16_bf16 v[64:79], v[246:249], v[250:253], v[64:79]
  v_xor_b32 v83, 0x1040, v80
  ds_read_b128 v[238:241], v83 offset:0
  s_waitcnt lgkmcnt(6)
  v_mfma_f32_32x32x16_bf16 v[16:31], v[218:221], v[174:177], v[16:31]
  ds_read_b64_tr_b16 v[242:243], v84 offset:22528
  ds_read_b64_tr_b16 v[244:245], v84 offset:23040
  v_mfma_f32_32x32x16_bf16 v[32:47], v[222:225], v[174:177], v[32:47]
  v_xor_b32 v82, 0x60, v80
  ds_read_b128 v[182:185], v82 offset:0
  v_mfma_f32_32x32x16_bf16 v[48:63], v[218:221], v[226:229], v[48:63]
  ds_read_b64_tr_b16 v[246:247], v85 offset:22528
  ds_read_b64_tr_b16 v[248:249], v85 offset:23040
  v_mfma_f32_32x32x16_bf16 v[64:79], v[222:225], v[226:229], v[64:79]
  v_xor_b32 v83, 0x1060, v80
  ds_read_b128 v[250:253], v83 offset:0
  s_waitcnt lgkmcnt(6)
  v_mfma_f32_32x32x16_bf16 v[16:31], v[230:233], v[178:181], v[16:31]
  s_barrier
  s_add_u32 s76, s85, 0
  v_add_u32 v84, s76, v81
  v_xor_b32 v85, 64, v84
  v_mfma_f32_32x32x16_bf16 v[32:47], v[234:237], v[178:181], v[32:47]
  ds_read_b64_tr_b16 v[218:219], v84 offset:49152
  ds_read_b64_tr_b16 v[220:221], v84 offset:49664
  v_mfma_f32_32x32x16_bf16 v[48:63], v[230:233], v[238:241], v[48:63]
  v_xor_b32 v82, 0x0, v80
  ds_read_b128 v[186:189], v82 offset:32768
  ds_read_b64_tr_b16 v[222:223], v85 offset:49152
  v_mfma_f32_32x32x16_bf16 v[64:79], v[234:237], v[238:241], v[64:79]
  ds_read_b64_tr_b16 v[224:225], v85 offset:49664
  v_xor_b32 v83, 0x1000, v80
  ds_read_b128 v[226:229], v83 offset:32768
  s_waitcnt lgkmcnt(6)
  v_mfma_f32_32x32x16_bf16 v[16:31], v[242:245], v[182:185], v[16:31]
  ds_read_b64_tr_b16 v[230:231], v84 offset:51200
  ds_read_b64_tr_b16 v[232:233], v84 offset:51712
  v_mfma_f32_32x32x16_bf16 v[32:47], v[246:249], v[182:185], v[32:47]
  v_xor_b32 v82, 0x20, v80
  ds_read_b128 v[190:193], v82 offset:32768
  v_mfma_f32_32x32x16_bf16 v[48:63], v[242:245], v[250:253], v[48:63]
  ds_read_b64_tr_b16 v[234:235], v85 offset:51200
  ds_read_b64_tr_b16 v[236:237], v85 offset:51712
  v_mfma_f32_32x32x16_bf16 v[64:79], v[246:249], v[250:253], v[64:79]
  v_xor_b32 v83, 0x1020, v80
  ds_read_b128 v[238:241], v83 offset:32768
  s_waitcnt lgkmcnt(6)
  v_mfma_f32_32x32x16_bf16 v[16:31], v[218:221], v[186:189], v[16:31]
  ds_read_b64_tr_b16 v[242:243], v84 offset:53248
  ds_read_b64_tr_b16 v[244:245], v84 offset:53760
  v_mfma_f32_32x32x16_bf16 v[32:47], v[222:225], v[186:189], v[32:47]
  v_xor_b32 v82, 0x40, v80
  ds_read_b128 v[194:197], v82 offset:32768
  v_mfma_f32_32x32x16_bf16 v[48:63], v[218:221], v[226:229], v[48:63]
  ds_read_b64_tr_b16 v[246:247], v85 offset:53248
  ds_read_b64_tr_b16 v[248:249], v85 offset:53760
  v_mfma_f32_32x32x16_bf16 v[64:79], v[222:225], v[226:229], v[64:79]
  v_xor_b32 v83, 0x1040, v80
  ds_read_b128 v[250:253], v83 offset:32768
  s_waitcnt lgkmcnt(6)
  v_mfma_f32_32x32x16_bf16 v[16:31], v[230:233], v[190:193], v[16:31]
  ds_read_b64_tr_b16 v[218:219], v84 offset:55296
  ds_read_b64_tr_b16 v[220:221], v84 offset:55808
  v_mfma_f32_32x32x16_bf16 v[32:47], v[234:237], v[190:193], v[32:47]
  v_xor_b32 v82, 0x60, v80
  ds_read_b128 v[198:201], v82 offset:32768
  v_mfma_f32_32x32x16_bf16 v[48:63], v[230:233], v[238:241], v[48:63]
  ds_read_b64_tr_b16 v[222:223], v85 offset:55296
  ds_read_b64_tr_b16 v[224:225], v85 offset:55808
  v_mfma_f32_32x32x16_bf16 v[64:79], v[234:237], v[238:241], v[64:79]
  v_xor_b32 v83, 0x1060, v80
  ds_read_b128 v[226:229], v83 offset:32768
  s_waitcnt lgkmcnt(6)
  v_mfma_f32_32x32x16_bf16 v[16:31], v[242:245], v[194:197], v[16:31]
  s_barrier
  s_add_u32 s76, s85, 65536
  v_add_u32 v84, s76, v81
  v_xor_b32 v85, 64, v84
  v_mfma_f32_32x32x16_bf16 v[32:47], v[246:249], v[194:197], v[32:47]
  ds_read_b64_tr_b16 v[230:231], v84 offset:16384
  ds_read_b64_tr_b16 v[232:233], v84 offset:16896
  v_mfma_f32_32x32x16_bf16 v[48:63], v[242:245], v[250:253], v[48:63]
  v_xor_b32 v82, 0x10000, v80
  ds_read_b128 v[202:205], v82 offset:0
  ds_read_b64_tr_b16 v[234:235], v85 offset:16384
  v_mfma_f32_32x32x16_bf16 v[64:79], v[246:249], v[250:253], v[64:79]
  ds_read_b64_tr_b16 v[236:237], v85 offset:16896
  v_xor_b32 v83, 0x11000, v80
  ds_read_b128 v[238:241], v83 offset:0
  s_waitcnt lgkmcnt(6)
  v_mfma_f32_32x32x16_bf16 v[16:31], v[218:221], v[198:201], v[16:31]
  ds_read_b64_tr_b16 v[242:243], v84 offset:18432
  ds_read_b64_tr_b16 v[244:245], v84 offset:18944
  v_mfma_f32_32x32x16_bf16 v[32:47], v[222:225], v[198:201], v[32:47]
  v_xor_b32 v82, 0x10020, v80
  ds_read_b128 v[206:209], v82 offset:0
  v_mfma_f32_32x32x16_bf16 v[48:63], v[218:221], v[226:229], v[48:63]
  ds_read_b64_tr_b16 v[246:247], v85 offset:18432
  ds_read_b64_tr_b16 v[248:249], v85 offset:18944
  v_mfma_f32_32x32x16_bf16 v[64:79], v[222:225], v[226:229], v[64:79]
  v_xor_b32 v83, 0x11020, v80
  ds_read_b128 v[250:253], v83 offset:0
  s_waitcnt lgkmcnt(6)
  v_mfma_f32_32x32x16_bf16 v[16:31], v[230:233], v[202:205], v[16:31]
  ds_read_b64_tr_b16 v[218:219], v84 offset:20480
  ds_read_b64_tr_b16 v[220:221], v84 offset:20992
  v_mfma_f32_32x32x16_bf16 v[32:47], v[234:237], v[202:205], v[32:47]
  v_xor_b32 v82, 0x10040, v80
  ds_read_b128 v[210:213], v82 offset:0
  v_mfma_f32_32x32x16_bf16 v[48:63], v[230:233], v[238:241], v[48:63]
  ds_read_b64_tr_b16 v[222:223], v85 offset:20480
  ds_read_b64_tr_b16 v[224:225], v85 offset:20992
  v_mfma_f32_32x32x16_bf16 v[64:79], v[234:237], v[238:241], v[64:79]
  v_xor_b32 v83, 0x11040, v80
  ds_read_b128 v[226:229], v83 offset:0
  s_waitcnt lgkmcnt(6)
  v_mfma_f32_32x32x16_bf16 v[16:31], v[242:245], v[206:209], v[16:31]
  ds_read_b64_tr_b16 v[230:231], v84 offset:22528
  ds_read_b64_tr_b16 v[232:233], v84 offset:23040
  v_mfma_f32_32x32x16_bf16 v[32:47], v[246:249], v[206:209], v[32:47]
  v_xor_b32 v82, 0x10060, v80
  ds_read_b128 v[214:217], v82 offset:0
  v_mfma_f32_32x32x16_bf16 v[48:63], v[242:245], v[250:253], v[48:63]
  ds_read_b64_tr_b16 v[234:235], v85 offset:22528
  ds_read_b64_tr_b16 v[236:237], v85 offset:23040
  v_mfma_f32_32x32x16_bf16 v[64:79], v[246:249], v[250:253], v[64:79]
  v_xor_b32 v83, 0x11060, v80
  ds_read_b128 v[238:241], v83 offset:0
  s_waitcnt lgkmcnt(6)
  v_mfma_f32_32x32x16_bf16 v[16:31], v[218:221], v[210:213], v[16:31]
  s_waitcnt vmcnt(0)
  s_mov_b32 s16, s66
  s_mov_b32 s17, s67
  s_mov_b32 s18, 0x100
  s_mov_b32 s19, 0x20000
  buffer_load_dword v6, off, s[16:19], 0 sc1
  v_mfma_f32_32x32x16_bf16 v[32:47], v[222:225], v[210:213], v[32:47]
  v_mfma_f32_32x32x16_bf16 v[48:63], v[218:221], v[226:229], v[48:63]
  v_mfma_f32_32x32x16_bf16 v[64:79], v[222:225], v[226:229], v[64:79]
  s_waitcnt lgkmcnt(0)
  v_mfma_f32_32x32x16_bf16 v[16:31], v[230:233], v[214:217], v[16:31]
  v_mfma_f32_32x32x16_bf16 v[32:47], v[234:237], v[214:217], v[32:47]
  v_mfma_f32_32x32x16_bf16 v[48:63], v[230:233], v[238:241], v[48:63]
  v_mfma_f32_32x32x16_bf16 v[64:79], v[234:237], v[238:241], v[64:79]
  s_lshl_b32 s76, s88, 12
  s_cmp_lg_u32 s85, 0
  s_cbranch_scc1 G_vout
  v_add_u32 v4, s76, v5
  v_xor_b32 v2, 4096, v4
  s_nop 3
  v_cvt_pk_bf16_f32 v218, v16, v17
  v_cvt_pk_bf16_f32 v219, v18, v19
  v_cvt_pk_bf16_f32 v220, v20, v21
  v_cvt_pk_bf16_f32 v221, v22, v23
  v_cvt_pk_bf16_f32 v222, v24, v25
  v_cvt_pk_bf16_f32 v223, v26, v27
  v_cvt_pk_bf16_f32 v224, v28, v29
  v_cvt_pk_bf16_f32 v225, v30, v31
  ds_write_b128 v4, v[218:221] offset:0
  ds_write_b128 v4, v[222:225] offset:1024
  v_cvt_pk_bf16_f32 v226, v32, v33
  v_cvt_pk_bf16_f32 v227, v34, v35
  v_cvt_pk_bf16_f32 v228, v36, v37
  v_cvt_pk_bf16_f32 v229, v38, v39
  v_cvt_pk_bf16_f32 v230, v40, v41
  v_cvt_pk_bf16_f32 v231, v42, v43
  v_cvt_pk_bf16_f32 v232, v44, v45
  v_cvt_pk_bf16_f32 v233, v46, v47
  ds_write_b128 v4, v[226:229] offset:2048
  ds_write_b128 v4, v[230:233] offset:3072
  v_cvt_pk_bf16_f32 v234, v48, v49
  v_cvt_pk_bf16_f32 v235, v50, v51
  v_cvt_pk_bf16_f32 v236, v52, v53
  v_cvt_pk_bf16_f32 v237, v54, v55
  v_cvt_pk_bf16_f32 v238, v56, v57
  v_cvt_pk_bf16_f32 v239, v58, v59
  v_cvt_pk_bf16_f32 v240, v60, v61
  v_cvt_pk_bf16_f32 v241, v62, v63
  ds_write_b128 v2, v[234:237] offset:0
  ds_write_b128 v2, v[238:241] offset:1024
  v_cvt_pk_bf16_f32 v242, v64, v65
  v_cvt_pk_bf16_f32 v243, v66, v67
  v_cvt_pk_bf16_f32 v244, v68, v69
  v_cvt_pk_bf16_f32 v245, v70, v71
  v_cvt_pk_bf16_f32 v246, v72, v73
  v_cvt_pk_bf16_f32 v247, v74, v75
  v_cvt_pk_bf16_f32 v248, v76, v77
  v_cvt_pk_bf16_f32 v249, v78, v79
  ds_write_b128 v2, v[242:245] offset:2048
  ds_write_b128 v2, v[246:249] offset:3072
  s_branch G_outd
G_vout:
  v_and_b32 v4, 31, v1
  v_lshlrev_b32 v4, 6, v4
  v_lshl_add_u32 v4, v3, 3, v4
  v_bfe_u32 v2, v1, 1, 2
  v_lshl_add_u32 v4, v2, 4, v4
  v_add_u32 v4, s76, v4
  v_cvt_pk_bf16_f32 v218, v16, v17
  v_cvt_pk_bf16_f32 v219, v18, v19
  v_cvt_pk_bf16_f32 v220, v20, v21
  v_cvt_pk_bf16_f32 v221, v22, v23
  v_cvt_pk_bf16_f32 v222, v24, v25
  v_cvt_pk_bf16_f32 v223, v26, v27
  v_cvt_pk_bf16_f32 v224, v28, v29
  v_cvt_pk_bf16_f32 v225, v30, v31
  v_xor_b32 v2, 0, v4
  ds_write_b64 v2, v[218:219] offset:16384
  v_xor_b32 v2, 16, v4
  ds_write_b64 v2, v[220:221] offset:16384
  v_xor_b32 v2, 32, v4
  ds_write_b64 v2, v[222:223] offset:16384
  v_xor_b32 v2, 48, v4
  ds_write_b64 v2, v[224:225] offset:16384
  v_cvt_pk_bf16_f32 v226, v32, v33
  v_cvt_pk_bf16_f32 v227, v34, v35
  v_cvt_pk_bf16_f32 v228, v36, v37
  v_cvt_pk_bf16_f32 v229, v38, v39
  v_cvt_pk_bf16_f32 v230, v40, v41
  v_cvt_pk_bf16_f32 v231, v42, v43
  v_cvt_pk_bf16_f32 v232, v44, v45
  v_cvt_pk_bf16_f32 v233, v46, v47
  v_xor_b32 v2, 0, v4
  ds_write_b64 v2, v[226:227] offset:18432
  v_xor_b32 v2, 16, v4
  ds_write_b64 v2, v[228:229] offset:18432
  v_xor_b32 v2, 32, v4
  ds_write_b64 v2, v[230:231] offset:18432
  v_xor_b32 v2, 48, v4
  ds_write_b64 v2, v[232:233] offset:18432
  v_cvt_pk_bf16_f32 v234, v48, v49
  v_cvt_pk_bf16_f32 v235, v50, v51
  v_cvt_pk_bf16_f32 v236, v52, v53
  v_cvt_pk_bf16_f32 v237, v54, v55
  v_cvt_pk_bf16_f32 v238, v56, v57
  v_cvt_pk_bf16_f32 v239, v58, v59
  v_cvt_pk_bf16_f32 v240, v60, v61
  v_cvt_pk_bf16_f32 v241, v62, v63
  v_xor_b32 v2, 4096, v4
  ds_write_b64 v2, v[234:235] offset:16384
  v_xor_b32 v2, 4112, v4
  ds_write_b64 v2, v[236:237] offset:16384
  v_xor_b32 v2, 4128, v4
  ds_write_b64 v2, v[238:239] offset:16384
  v_xor_b32 v2, 4144, v4
  ds_write_b64 v2, v[240:241] offset:16384
  v_cvt_pk_bf16_f32 v242, v64, v65
  v_cvt_pk_bf16_f32 v243, v66, v67
  v_cvt_pk_bf16_f32 v244, v68, v69
  v_cvt_pk_bf16_f32 v245, v70, v71
  v_cvt_pk_bf16_f32 v246, v72, v73
  v_cvt_pk_bf16_f32 v247, v74, v75
  v_cvt_pk_bf16_f32 v248, v76, v77
  v_cvt_pk_bf16_f32 v249, v78, v79
  v_xor_b32 v2, 4096, v4
  ds_write_b64 v2, v[242:243] offset:18432
  v_xor_b32 v2, 4112, v4
  ds_write_b64 v2, v[244:245] offset:18432
  v_xor_b32 v2, 4128, v4
  ds_write_b64 v2, v[246:247] offset:18432
  v_xor_b32 v2, 4144, v4
  ds_write_b64 v2, v[248:249] offset:18432
G_outd:
  v_add_u32 v84, 0x10000, v81
  v_xor_b32 v85, 64, v84
  s_waitcnt lgkmcnt(0)
  s_barrier
  s_mov_b32 s28, s42
  s_mov_b32 s29, s43
  s_mov_b32 s30, 0x80000
  s_mov_b32 s31, 0x20000
  v_lshrrev_b32 v4, 4, v1
  v_lshlrev_b32 v80, 2, v4
  v_xor_b32 v80, v80, v1
  v_and_b32 v80, 15, v80
  v_lshlrev_b32 v80, 4, v80
  v_lshl_add_u32 v80, v4, 10, v80
  s_lshl_b32 s82, s72, 15
  s_lshl_b32 s83, s95, 8
  s_add_u32 s82, s82, s83
  s_lshl_b32 s83, s72, 13
  s_lshl_b32 s76, s88, 12
  s_lshl_b32 s77, s89, 11
  s_add_u32 s76, s76, s77
  v_add_u32 v2, s76, v5
  ds_read_b128 v[16:19], v2 offset:0
  ds_read_b128 v[20:23], v2 offset:1024
  s_waitcnt lgkmcnt(0)
  v_mfma_f32_32x32x16_bf16 v[24:39], v[8:11], v[16:19], 0
  v_mfma_f32_32x32x16_bf16 v[24:39], v[12:15], v[20:23], v[24:39]
  s_nop 11
  v_max3_f32 v56, v24, v25, v26
  s_add_u32 m0, s83, 65536
  s_add_u32 s84, s82, 0
  buffer_load_dwordx4 v80, s[28:31], s84 offen lds
  v_min3_f32 v57, v24, v25, v26
  v_max3_f32 v58, v27, v28, v29
  v_min3_f32 v59, v27, v28, v29
  v_max3_f32 v56, v56, v30, v31
  v_min3_f32 v57, v57, v30, v31
  v_max3_f32 v58, v58, v32, v33
  v_min3_f32 v59, v59, v32, v33
  v_max3_f32 v56, v56, v34, v35
  v_min3_f32 v57, v57, v34, v35
  v_max3_f32 v58, v58, v36, v37
  v_min3_f32 v59, v59, v36, v37
  v_max3_f32 v56, v56, v38, v39
  v_min3_f32 v57, v57, v38, v39
  v_max_f32 v56, v56, v58
  s_add_u32 m0, s83, 66560
  s_add_u32 s84, s82, 4096
  buffer_load_dwordx4 v80, s[28:31], s84 offen lds
  v_min_f32 v57, v57, v59
  v_pk_mul_f32 v[56:57], v[56:57], s[90:91] neg_lo:[0,1]
  v_pk_fma_f32 v[40:41], v[24:25], s[90:91], v[56:57] op_sel:[0,0,1] op_sel_hi:[1,1,1] neg_lo:[1,0,0] neg_hi:[1,0,0]
  v_pk_fma_f32 v[24:25], v[24:25], s[90:91], v[56:57] op_sel:[0,0,0] op_sel_hi:[1,1,0]
  v_pk_fma_f32 v[42:43], v[26:27], s[90:91], v[56:57] op_sel:[0,0,1] op_sel_hi:[1,1,1] neg_lo:[1,0,0] neg_hi:[1,0,0]
  v_pk_fma_f32 v[26:27], v[26:27], s[90:91], v[56:57] op_sel:[0,0,0] op_sel_hi:[1,1,0]
  v_pk_fma_f32 v[44:45], v[28:29], s[90:91], v[56:57] op_sel:[0,0,1] op_sel_hi:[1,1,1] neg_lo:[1,0,0] neg_hi:[1,0,0]
  v_pk_fma_f32 v[28:29], v[28:29], s[90:91], v[56:57] op_sel:[0,0,0] op_sel_hi:[1,1,0]
  v_pk_fma_f32 v[46:47], v[30:31], s[90:91], v[56:57] op_sel:[0,0,1] op_sel_hi:[1,1,1] neg_lo:[1,0,0] neg_hi:[1,0,0]
  v_pk_fma_f32 v[30:31], v[30:31], s[90:91], v[56:57] op_sel:[0,0,0] op_sel_hi:[1,1,0]
  v_pk_fma_f32 v[48:49], v[32:33], s[90:91], v[56:57] op_sel:[0,0,1] op_sel_hi:[1,1,1] neg_lo:[1,0,0] neg_hi:[1,0,0]
  v_pk_fma_f32 v[32:33], v[32:33], s[90:91], v[56:57] op_sel:[0,0,0] op_sel_hi:[1,1,0]
  v_pk_fma_f32 v[50:51], v[34:35], s[90:91], v[56:57] op_sel:[0,0,1] op_sel_hi:[1,1,1] neg_lo:[1,0,0] neg_hi:[1,0,0]
  v_pk_fma_f32 v[34:35], v[34:35], s[90:91], v[56:57] op_sel:[0,0,0] op_sel_hi:[1,1,0]
  s_add_u32 m0, s83, 67584
  s_add_u32 s84, s82, 8192
  buffer_load_dwordx4 v80, s[28:31], s84 offen lds
  v_pk_fma_f32 v[52:53], v[36:37], s[90:91], v[56:57] op_sel:[0,0,1] op_sel_hi:[1,1,1] neg_lo:[1,0,0] neg_hi:[1,0,0]
  v_pk_fma_f32 v[36:37], v[36:37], s[90:91], v[56:57] op_sel:[0,0,0] op_sel_hi:[1,1,0]
  v_pk_fma_f32 v[54:55], v[38:39], s[90:91], v[56:57] op_sel:[0,0,1] op_sel_hi:[1,1,1] neg_lo:[1,0,0] neg_hi:[1,0,0]
  v_pk_fma_f32 v[38:39], v[38:39], s[90:91], v[56:57] op_sel:[0,0,0] op_sel_hi:[1,1,0]
  v_exp_f32 v24, v24
  v_exp_f32 v40, v40
  v_exp_f32 v25, v25
  v_exp_f32 v41, v41
  v_exp_f32 v26, v26
  v_exp_f32 v42, v42
  v_exp_f32 v27, v27
  v_exp_f32 v43, v43
  v_exp_f32 v28, v28
  v_exp_f32 v44, v44
  v_exp_f32 v29, v29
  s_add_u32 m0, s83, 68608
  s_add_u32 s84, s82, 12288
  buffer_load_dwordx4 v80, s[28:31], s84 offen lds
  v_exp_f32 v45, v45
  v_exp_f32 v30, v30
  v_exp_f32 v46, v46
  v_exp_f32 v31, v31
  v_exp_f32 v47, v47
  v_exp_f32 v32, v32
  v_exp_f32 v48, v48
  v_exp_f32 v33, v33
  v_exp_f32 v49, v49
  v_exp_f32 v34, v34
  v_exp_f32 v50, v50
  v_exp_f32 v35, v35
  v_exp_f32 v51, v51
  v_exp_f32 v36, v36
  s_add_u32 m0, s83, 69632
  s_add_u32 s84, s82, 16384
  buffer_load_dwordx4 v80, s[28:31], s84 offen lds
  v_exp_f32 v52, v52
  v_exp_f32 v37, v37
  v_exp_f32 v53, v53
  v_exp_f32 v38, v38
  v_exp_f32 v54, v54
  v_exp_f32 v39, v39
  v_exp_f32 v55, v55
  v_pk_add_f32 v[64:65], v[24:25], v[26:27]
  v_pk_add_f32 v[68:69], v[40:41], v[42:43]
  v_pk_add_f32 v[66:67], v[28:29], v[30:31]
  v_pk_add_f32 v[70:71], v[44:45], v[46:47]
  v_pk_add_f32 v[64:65], v[64:65], v[32:33]
  v_pk_add_f32 v[68:69], v[68:69], v[48:49]
  v_pk_add_f32 v[66:67], v[66:67], v[34:35]
  s_add_u32 m0, s83, 70656
  s_add_u32 s84, s82, 20480
  buffer_load_dwordx4 v80, s[28:31], s84 offen lds
  v_pk_add_f32 v[70:71], v[70:71], v[50:51]
  v_pk_add_f32 v[64:65], v[64:65], v[36:37]
  v_pk_add_f32 v[68:69], v[68:69], v[52:53]
  v_pk_add_f32 v[66:67], v[66:67], v[38:39]
  v_pk_add_f32 v[70:71], v[70:71], v[54:55]
  v_pk_add_f32 v[64:65], v[64:65], v[66:67]
  v_pk_add_f32 v[68:69], v[68:69], v[70:71]
  v_add_f32 v60, v64, v65
  v_add_f32 v61, v68, v69
  v_rcp_f32 v60, v60
  v_rcp_f32 v61, v61
  s_nop 0
  v_pk_mul_f32 v[24:25], v[24:25], v[60:61] op_sel:[0,0] op_sel_hi:[1,0]
  v_pk_mul_f32 v[40:41], v[40:41], v[60:61] op_sel:[0,1] op_sel_hi:[1,1]
  v_pk_mul_f32 v[26:27], v[26:27], v[60:61] op_sel:[0,0] op_sel_hi:[1,0]
  v_pk_mul_f32 v[42:43], v[42:43], v[60:61] op_sel:[0,1] op_sel_hi:[1,1]
  s_add_u32 m0, s83, 71680
  s_add_u32 s84, s82, 24576
  buffer_load_dwordx4 v80, s[28:31], s84 offen lds
  v_pk_mul_f32 v[28:29], v[28:29], v[60:61] op_sel:[0,0] op_sel_hi:[1,0]
  v_pk_mul_f32 v[44:45], v[44:45], v[60:61] op_sel:[0,1] op_sel_hi:[1,1]
  v_pk_mul_f32 v[30:31], v[30:31], v[60:61] op_sel:[0,0] op_sel_hi:[1,0]
  v_pk_mul_f32 v[46:47], v[46:47], v[60:61] op_sel:[0,1] op_sel_hi:[1,1]
  v_pk_mul_f32 v[32:33], v[32:33], v[60:61] op_sel:[0,0] op_sel_hi:[1,0]
  v_pk_mul_f32 v[48:49], v[48:49], v[60:61] op_sel:[0,1] op_sel_hi:[1,1]
  v_pk_mul_f32 v[34:35], v[34:35], v[60:61] op_sel:[0,0] op_sel_hi:[1,0]
  v_pk_mul_f32 v[50:51], v[50:51], v[60:61] op_sel:[0,1] op_sel_hi:[1,1]
  v_pk_mul_f32 v[36:37], v[36:37], v[60:61] op_sel:[0,0] op_sel_hi:[1,0]
  v_pk_mul_f32 v[52:53], v[52:53], v[60:61] op_sel:[0,1] op_sel_hi:[1,1]
  v_pk_mul_f32 v[38:39], v[38:39], v[60:61] op_sel:[0,0] op_sel_hi:[1,0]
  v_pk_mul_f32 v[54:55], v[54:55], v[60:61] op_sel:[0,1] op_sel_hi:[1,1]
  v_cvt_pk_bf16_f32 v64, v24, v25
  v_cvt_pk_bf16_f32 v65, v26, v27
  s_add_u32 m0, s83, 72704
  s_add_u32 s84, s82, 28672
  buffer_load_dwordx4 v80, s[28:31], s84 offen lds
  v_cvt_pk_bf16_f32 v66, v28, v29
  v_cvt_pk_bf16_f32 v67, v30, v31
  v_cvt_pk_bf16_f32 v68, v32, v33
  v_cvt_pk_bf16_f32 v69, v34, v35
  v_cvt_pk_bf16_f32 v70, v36, v37
  v_cvt_pk_bf16_f32 v71, v38, v39
  v_cvt_pk_bf16_f32 v72, v40, v41
  v_cvt_pk_bf16_f32 v73, v42, v43
  v_cvt_pk_bf16_f32 v74, v44, v45
  v_cvt_pk_bf16_f32 v75, v46, v47
  v_cvt_pk_bf16_f32 v76, v48, v49
  v_cvt_pk_bf16_f32 v77, v50, v51
  v_cvt_pk_bf16_f32 v78, v52, v53
  v_cvt_pk_bf16_f32 v79, v54, v55
  ds_write_b128 v7, v[64:67]
  v_xor_b32 v2, 16, v7
  ds_write_b128 v2, v[68:71]
  v_xor_b32 v2, 32, v7
  ds_write_b128 v2, v[72:75]
  v_xor_b32 v2, 48, v7
  ds_write_b128 v2, v[76:79]
  s_waitcnt lgkmcnt(0)
  v_add_u32 v82, 0x20000, v81
  v_xor_b32 v83, 64, v82
  ds_read_b64_tr_b16 v[218:219], v84 offset:32768
  ds_read_b64_tr_b16 v[220:221], v84 offset:33280
  ds_read_b64_tr_b16 v[222:223], v85 offset:32768
  ds_read_b64_tr_b16 v[224:225], v85 offset:33280
  ds_read_b64_tr_b16 v[226:227], v84 offset:34816
  ds_read_b64_tr_b16 v[228:229], v84 offset:35328
  ds_read_b64_tr_b16 v[230:231], v85 offset:34816
  ds_read_b64_tr_b16 v[232:233], v85 offset:35328
  ds_read_b64_tr_b16 v[234:235], v84 offset:36864
  ds_read_b64_tr_b16 v[236:237], v84 offset:37376
  ds_read_b64_tr_b16 v[238:239], v85 offset:36864
  ds_read_b64_tr_b16 v[240:241], v85 offset:37376
  ds_read_b64_tr_b16 v[242:243], v84 offset:38912
  ds_read_b64_tr_b16 v[244:245], v84 offset:39424
  ds_read_b64_tr_b16 v[246:247], v85 offset:38912
  ds_read_b64_tr_b16 v[248:249], v85 offset:39424
  s_waitcnt lgkmcnt(12)
  v_mfma_f32_32x32x16_bf16 v[24:39], v[218:221], v[90:93], 0
  ds_read_b64_tr_b16 v[56:57], v84 offset:40960
  ds_read_b64_tr_b16 v[58:59], v84 offset:41472
  v_mfma_f32_32x32x16_bf16 v[40:55], v[222:225], v[90:93], 0
  ds_read_b64_tr_b16 v[60:61], v85 offset:40960
  ds_read_b64_tr_b16 v[62:63], v85 offset:41472
  s_waitcnt lgkmcnt(12)
  v_mfma_f32_32x32x16_bf16 v[24:39], v[226:229], v[94:97], v[24:39]
  ds_read_b64_tr_b16 v[64:65], v84 offset:43008
  ds_read_b64_tr_b16 v[66:67], v84 offset:43520
  v_mfma_f32_32x32x16_bf16 v[40:55], v[230:233], v[94:97], v[40:55]
  ds_read_b64_tr_b16 v[68:69], v85 offset:43008
  ds_read_b64_tr_b16 v[70:71], v85 offset:43520
  s_waitcnt lgkmcnt(12)
  v_mfma_f32_32x32x16_bf16 v[24:39], v[234:237], v[98:101], v[24:39]
  ds_read_b64_tr_b16 v[218:219], v84 offset:45056
  ds_read_b64_tr_b16 v[220:221], v84 offset:45568
  v_mfma_f32_32x32x16_bf16 v[40:55], v[238:241], v[98:101], v[40:55]
  ds_read_b64_tr_b16 v[222:223], v85 offset:45056
  ds_read_b64_tr_b16 v[224:225], v85 offset:45568
  s_waitcnt lgkmcnt(12)
  v_mfma_f32_32x32x16_bf16 v[24:39], v[242:245], v[102:105], v[24:39]
  s_barrier
  ds_read_b64_tr_b16 v[226:227], v84 offset:47104
  ds_read_b64_tr_b16 v[228:229], v84 offset:47616
  v_mfma_f32_32x32x16_bf16 v[40:55], v[246:249], v[102:105], v[40:55]
  ds_read_b64_tr_b16 v[230:231], v85 offset:47104
  ds_read_b64_tr_b16 v[232:233], v85 offset:47616
  s_waitcnt lgkmcnt(12)
  v_mfma_f32_32x32x16_bf16 v[24:39], v[56:59], v[106:109], v[24:39]
  ds_read_b64_tr_b16 v[234:235], v84 offset:49152
  ds_read_b64_tr_b16 v[236:237], v84 offset:49664
  ds_read_b64_tr_b16 v[238:239], v85 offset:49152
  v_mfma_f32_32x32x16_bf16 v[40:55], v[60:63], v[106:109], v[40:55]
  ds_read_b64_tr_b16 v[240:241], v85 offset:49664
  s_mov_b32 s70, 65536
  s_mov_b32 s71, 131072
  s_waitcnt lgkmcnt(12)
  v_mfma_f32_32x32x16_bf16 v[24:39], v[64:67], v[110:113], v[24:39]
  ds_read_b64_tr_b16 v[242:243], v84 offset:51200
  ds_read_b64_tr_b16 v[244:245], v84 offset:51712
  ds_read_b64_tr_b16 v[246:247], v85 offset:51200
  v_mfma_f32_32x32x16_bf16 v[40:55], v[68:71], v[110:113], v[40:55]
  ds_read_b64_tr_b16 v[248:249], v85 offset:51712
  s_mov_b32 s92, 2
  s_lshl_b32 s86, s74, 11
  s_waitcnt lgkmcnt(12)
  v_mfma_f32_32x32x16_bf16 v[24:39], v[218:221], v[114:117], v[24:39]
  ds_read_b64_tr_b16 v[56:57], v84 offset:53248
  ds_read_b64_tr_b16 v[58:59], v84 offset:53760
  ds_read_b64_tr_b16 v[60:61], v85 offset:53248
  v_mfma_f32_32x32x16_bf16 v[40:55], v[222:225], v[114:117], v[40:55]
  ds_read_b64_tr_b16 v[62:63], v85 offset:53760
  s_add_u32 s86, s86, 69632
  v_lshlrev_b32 v80, 7, v1
  s_waitcnt lgkmcnt(12)
  v_mfma_f32_32x32x16_bf16 v[24:39], v[226:229], v[118:121], v[24:39]
  ds_read_b64_tr_b16 v[64:65], v84 offset:55296
  ds_read_b64_tr_b16 v[66:67], v84 offset:55808
  ds_read_b64_tr_b16 v[68:69], v85 offset:55296
  v_mfma_f32_32x32x16_bf16 v[40:55], v[230:233], v[118:121], v[40:55]
  ds_read_b64_tr_b16 v[70:71], v85 offset:55808
  s_lshl_b32 s83, s74, 1
  s_add_u32 s83, s83, s89
  s_waitcnt lgkmcnt(12)
  v_mfma_f32_32x32x16_bf16 v[24:39], v[234:237], v[122:125], v[24:39]
  ds_read_b64_tr_b16 v[218:219], v84 offset:57344
  ds_read_b64_tr_b16 v[220:221], v84 offset:57856
  ds_read_b64_tr_b16 v[222:223], v85 offset:57344
  v_mfma_f32_32x32x16_bf16 v[40:55], v[238:241], v[122:125], v[40:55]
  ds_read_b64_tr_b16 v[224:225], v85 offset:57856
  s_lshl_b32 s82, s83, 12
  v_and_b32 v7, 31, v1
  s_waitcnt lgkmcnt(12)
  v_mfma_f32_32x32x16_bf16 v[24:39], v[242:245], v[126:129], v[24:39]
  ds_read_b64_tr_b16 v[226:227], v84 offset:59392
  ds_read_b64_tr_b16 v[228:229], v84 offset:59904
  ds_read_b64_tr_b16 v[230:231], v85 offset:59392
  v_mfma_f32_32x32x16_bf16 v[40:55], v[246:249], v[126:129], v[40:55]
  ds_read_b64_tr_b16 v[232:233], v85 offset:59904
  v_lshlrev_b32 v7, 4, v7
  v_lshl_add_u32 v7, v3, 10, v7
  s_waitcnt lgkmcnt(12)
  v_mfma_f32_32x32x16_bf16 v[24:39], v[56:59], v[130:133], v[24:39]
  ds_read_b64_tr_b16 v[234:235], v84 offset:61440
  ds_read_b64_tr_b16 v[236:237], v84 offset:61952
  ds_read_b64_tr_b16 v[238:239], v85 offset:61440
  v_mfma_f32_32x32x16_bf16 v[40:55], v[60:63], v[130:133], v[40:55]
  ds_read_b64_tr_b16 v[240:241], v85 offset:61952
  s_lshl_b32 s84, s73, 2
  s_add_u32 s84, s84, s88
  s_waitcnt lgkmcnt(12)
  v_mfma_f32_32x32x16_bf16 v[24:39], v[64:67], v[134:137], v[24:39]
  ds_read_b64_tr_b16 v[242:243], v84 offset:63488
  ds_read_b64_tr_b16 v[244:245], v84 offset:64000
  ds_read_b64_tr_b16 v[246:247], v85 offset:63488
  v_mfma_f32_32x32x16_bf16 v[40:55], v[68:71], v[134:137], v[40:55]
  ds_read_b64_tr_b16 v[248:249], v85 offset:64000
  s_lshl_b32 s84, s84, 15
  s_lshl_b32 s75, s83, 11
  s_waitcnt lgkmcnt(12)
  v_mfma_f32_32x32x16_bf16 v[24:39], v[218:221], v[138:141], v[24:39]
  ds_read_b64_tr_b16 v[56:57], v82 offset:0
  ds_read_b64_tr_b16 v[58:59], v82 offset:512
  ds_read_b64_tr_b16 v[60:61], v83 offset:0
  v_mfma_f32_32x32x16_bf16 v[40:55], v[222:225], v[138:141], v[40:55]
  ds_read_b64_tr_b16 v[62:63], v83 offset:512
  s_add_u32 s84, s84, s75
  s_lshl_b32 s83, s83, 8
  s_waitcnt lgkmcnt(12)
  v_mfma_f32_32x32x16_bf16 v[24:39], v[226:229], v[142:145], v[24:39]
  ds_read_b64_tr_b16 v[64:65], v82 offset:2048
  ds_read_b64_tr_b16 v[66:67], v82 offset:2560
  ds_read_b64_tr_b16 v[68:69], v83 offset:2048
  v_mfma_f32_32x32x16_bf16 v[40:55], v[230:233], v[142:145], v[40:55]
  ds_read_b64_tr_b16 v[70:71], v83 offset:2560
  s_add_u32 s83, s83, 65536
  s_lshl_b32 s75, s72, 12
  s_waitcnt lgkmcnt(12)
  v_mfma_f32_32x32x16_bf16 v[24:39], v[234:237], v[146:149], v[24:39]
  ds_read_b64_tr_b16 v[218:219], v82 offset:4096
  ds_read_b64_tr_b16 v[220:221], v82 offset:4608
  ds_read_b64_tr_b16 v[222:223], v83 offset:4096
  v_mfma_f32_32x32x16_bf16 v[40:55], v[238:241], v[146:149], v[40:55]
  ds_read_b64_tr_b16 v[224:225], v83 offset:4608
  s_add_u32 s75, s75, 131072
  v_lshl_add_u32 v86, v1, 3, s75
  s_waitcnt lgkmcnt(12)
  v_mfma_f32_32x32x16_bf16 v[24:39], v[242:245], v[150:153], v[24:39]
  ds_read_b64_tr_b16 v[226:227], v82 offset:6144
  ds_read_b64_tr_b16 v[228:229], v82 offset:6656
  ds_read_b64_tr_b16 v[230:231], v83 offset:6144
  v_mfma_f32_32x32x16_bf16 v[40:55], v[246:249], v[150:153], v[40:55]
  ds_read_b64_tr_b16 v[232:233], v83 offset:6656
  v_bfe_u32 v252, v1, 2, 1
  v_lshlrev_b32 v87, 10, v252
  s_waitcnt lgkmcnt(12)
  v_mfma_f32_32x32x16_bf16 v[24:39], v[56:59], v[154:157], v[24:39]
  ds_read_b64_tr_b16 v[234:235], v82 offset:8192
  ds_read_b64_tr_b16 v[236:237], v82 offset:8704
  ds_read_b64_tr_b16 v[238:239], v83 offset:8192
  v_mfma_f32_32x32x16_bf16 v[40:55], v[60:63], v[154:157], v[40:55]
  ds_read_b64_tr_b16 v[240:241], v83 offset:8704
  v_xor_b32 v88, v252, v3
  v_and_b32 v252, 3, v1
  s_waitcnt lgkmcnt(12)
  v_mfma_f32_32x32x16_bf16 v[24:39], v[64:67], v[158:161], v[24:39]
  ds_read_b64_tr_b16 v[242:243], v82 offset:10240
  ds_read_b64_tr_b16 v[244:245], v82 offset:10752
  ds_read_b64_tr_b16 v[246:247], v83 offset:10240
  v_mfma_f32_32x32x16_bf16 v[40:55], v[68:71], v[158:161], v[40:55]
  ds_read_b64_tr_b16 v[248:249], v83 offset:10752
  v_lshl_add_u32 v87, v252, 6, v87
  v_bfe_u32 v252, v1, 3, 2
  s_waitcnt lgkmcnt(12)
  v_mfma_f32_32x32x16_bf16 v[24:39], v[218:221], v[162:165], v[24:39]
  ds_read_b64_tr_b16 v[56:57], v82 offset:12288
  ds_read_b64_tr_b16 v[58:59], v82 offset:12800
  ds_read_b64_tr_b16 v[60:61], v83 offset:12288
  v_mfma_f32_32x32x16_bf16 v[40:55], v[222:225], v[162:165], v[40:55]
  ds_read_b64_tr_b16 v[62:63], v83 offset:12800
  v_lshl_add_u32 v87, v252, 8, v87
  v_add_u32 v88, -1, v88
  s_waitcnt lgkmcnt(12)
  v_mfma_f32_32x32x16_bf16 v[24:39], v[226:229], v[166:169], v[24:39]
  ds_read_b64_tr_b16 v[64:65], v82 offset:14336
  ds_read_b64_tr_b16 v[66:67], v82 offset:14848
  ds_read_b64_tr_b16 v[68:69], v83 offset:14336
  v_mfma_f32_32x32x16_bf16 v[40:55], v[230:233], v[166:169], v[40:55]
  ds_read_b64_tr_b16 v[70:71], v83 offset:14848
  v_mov_b32 v252, 2560
  v_bfi_b32 v87, v88, v87, v252
  s_waitcnt lgkmcnt(12)
  v_mfma_f32_32x32x16_bf16 v[24:39], v[234:237], v[170:173], v[24:39]
  s_barrier
  ds_read_b64_tr_b16 v[218:219], v82 offset:16384
  ds_read_b64_tr_b16 v[220:221], v82 offset:16896
  ds_read_b64_tr_b16 v[222:223], v83 offset:16384
  v_mfma_f32_32x32x16_bf16 v[40:55], v[238:241], v[170:173], v[40:55]
  ds_read_b64_tr_b16 v[224:225], v83 offset:16896
  v_add_u32 v87, s75, v87
  v_lshl_add_u32 v88, v3, 6, s75
  s_waitcnt lgkmcnt(12)
  v_mfma_f32_32x32x16_bf16 v[24:39], v[242:245], v[174:177], v[24:39]
  ds_read_b64_tr_b16 v[226:227], v82 offset:18432
  ds_read_b64_tr_b16 v[228:229], v82 offset:18944
  ds_read_b64_tr_b16 v[230:231], v83 offset:18432
  v_mfma_f32_32x32x16_bf16 v[40:55], v[246:249], v[174:177], v[40:55]
  ds_read_b64_tr_b16 v[232:233], v83 offset:18944
  v_mov_b32 v252, 0
  v_mov_b32 v253, 0
  s_waitcnt lgkmcnt(12)
  v_mfma_f32_32x32x16_bf16 v[24:39], v[56:59], v[178:181], v[24:39]
  ds_read_b64_tr_b16 v[234:235], v82 offset:20480
  ds_read_b64_tr_b16 v[236:237], v82 offset:20992
  ds_read_b64_tr_b16 v[238:239], v83 offset:20480
  v_mfma_f32_32x32x16_bf16 v[40:55], v[60:63], v[178:181], v[40:55]
  ds_read_b64_tr_b16 v[240:241], v83 offset:20992
  s_lshl_b32 s3, s73, 3
  s_add_u32 s3, s3, s74
  s_waitcnt lgkmcnt(12)
  v_mfma_f32_32x32x16_bf16 v[24:39], v[64:67], v[182:185], v[24:39]
  ds_read_b64_tr_b16 v[242:243], v82 offset:22528
  ds_read_b64_tr_b16 v[244:245], v82 offset:23040
  ds_read_b64_tr_b16 v[246:247], v83 offset:22528
  v_mfma_f32_32x32x16_bf16 v[40:55], v[68:71], v[182:185], v[40:55]
  ds_read_b64_tr_b16 v[248:249], v83 offset:23040
  s_lshl_b32 s3, s3, 7
  s_add_u32 s3, s3, 86016
  s_waitcnt lgkmcnt(12)
  v_mfma_f32_32x32x16_bf16 v[24:39], v[218:221], v[186:189], v[24:39]
  ds_read_b64_tr_b16 v[56:57], v82 offset:24576
  ds_read_b64_tr_b16 v[58:59], v82 offset:25088
  v_mfma_f32_32x32x16_bf16 v[40:55], v[222:225], v[186:189], v[40:55]
  ds_read_b64_tr_b16 v[60:61], v83 offset:24576
  ds_read_b64_tr_b16 v[62:63], v83 offset:25088
  s_waitcnt lgkmcnt(12)
  v_mfma_f32_32x32x16_bf16 v[24:39], v[226:229], v[190:193], v[24:39]
  ds_read_b64_tr_b16 v[64:65], v82 offset:26624
  ds_read_b64_tr_b16 v[66:67], v82 offset:27136
  v_mfma_f32_32x32x16_bf16 v[40:55], v[230:233], v[190:193], v[40:55]
  ds_read_b64_tr_b16 v[68:69], v83 offset:26624
  ds_read_b64_tr_b16 v[70:71], v83 offset:27136
  s_waitcnt lgkmcnt(12)
  v_mfma_f32_32x32x16_bf16 v[24:39], v[234:237], v[194:197], v[24:39]
  ds_read_b64_tr_b16 v[218:219], v82 offset:28672
  ds_read_b64_tr_b16 v[220:221], v82 offset:29184
  v_mfma_f32_32x32x16_bf16 v[40:55], v[238:241], v[194:197], v[40:55]
  ds_read_b64_tr_b16 v[222:223], v83 offset:28672
  ds_read_b64_tr_b16 v[224:225], v83 offset:29184
  s_waitcnt lgkmcnt(12)
  v_mfma_f32_32x32x16_bf16 v[24:39], v[242:245], v[198:201], v[24:39]
  ds_read_b64_tr_b16 v[226:227], v82 offset:30720
  ds_read_b64_tr_b16 v[228:229], v82 offset:31232
  v_mfma_f32_32x32x16_bf16 v[40:55], v[246:249], v[198:201], v[40:55]
  ds_read_b64_tr_b16 v[230:231], v83 offset:30720
  ds_read_b64_tr_b16 v[232:233], v83 offset:31232
  s_waitcnt lgkmcnt(12)
  v_mfma_f32_32x32x16_bf16 v[24:39], v[56:59], v[202:205], v[24:39]
  v_mfma_f32_32x32x16_bf16 v[40:55], v[60:63], v[202:205], v[40:55]
  s_waitcnt lgkmcnt(8)
  v_mfma_f32_32x32x16_bf16 v[24:39], v[64:67], v[206:209], v[24:39]
  v_mfma_f32_32x32x16_bf16 v[40:55], v[68:71], v[206:209], v[40:55]
  s_waitcnt lgkmcnt(4)
  v_mfma_f32_32x32x16_bf16 v[24:39], v[218:221], v[210:213], v[24:39]
  v_mfma_f32_32x32x16_bf16 v[40:55], v[222:225], v[210:213], v[40:55]
  s_waitcnt lgkmcnt(0)
  v_mfma_f32_32x32x16_bf16 v[24:39], v[226:229], v[214:217], v[24:39]
  v_mfma_f32_32x32x16_bf16 v[40:55], v[230:233], v[214:217], v[40:55]
  s_lshl_b32 s76, s72, 11
  v_add_u32 v4, s76, v5
  s_nop 9
  v_cvt_pk_bf16_f32 v218, v40, v41
  v_cvt_pk_bf16_f32 v219, v42, v43
  v_cvt_pk_bf16_f32 v220, v44, v45
  v_cvt_pk_bf16_f32 v221, v46, v47
  v_cvt_pk_bf16_f32 v222, v48, v49
  v_cvt_pk_bf16_f32 v223, v50, v51
  v_cvt_pk_bf16_f32 v224, v52, v53
  v_cvt_pk_bf16_f32 v225, v54, v55
  ds_write_b128 v4, v[218:221] offset:0
  ds_write_b128 v4, v[222:225] offset:1024
  v_cvt_pk_bf16_f32 v16, v24, v25
  v_cvt_pk_bf16_f32 v17, v26, v27
  v_cvt_pk_bf16_f32 v18, v28, v29
  v_cvt_pk_bf16_f32 v19, v30, v31
  v_cvt_pk_bf16_f32 v20, v32, v33
  v_cvt_pk_bf16_f32 v21, v34, v35
  v_cvt_pk_bf16_f32 v22, v36, v37
  v_cvt_pk_bf16_f32 v23, v38, v39
  s_waitcnt vmcnt(8)
  s_mov_b32 s77, 0
G_cz_a:
  v_readfirstlane_b32 s76, v6
  s_nop 1
  s_cmp_ge_u32 s76, 8
  s_cbranch_scc1 G_cz_b
  buffer_load_dword v6, off, s[16:19], 0 sc1
  s_add_u32 s77, s77, 1
  s_cmp_ge_u32 s77, 65536
  s_cbranch_scc1 K_end
  s_waitcnt vmcnt(0)
  s_branch G_cz_a
G_cz_b:
  s_waitcnt lgkmcnt(0)
  s_barrier
G_epi:
  v_mfma_f32_32x32x16_bf16 v[24:39], v[8:11], v[16:19], 0
  v_mfma_f32_32x32x16_bf16 v[24:39], v[12:15], v[20:23], v[24:39]
  ds_write_b64 v86, v[252:253] offset:2560
  s_nop 10
  v_max3_f32 v56, v24, v25, v26
  v_min3_f32 v57, v24, v25, v26
  v_max3_f32 v58, v27, v28, v29
  v_min3_f32 v59, v27, v28, v29
  v_max3_f32 v56, v56, v30, v31
  v_min3_f32 v57, v57, v30, v31
  v_max3_f32 v58, v58, v32, v33
  v_min3_f32 v59, v59, v32, v33
  v_max3_f32 v56, v56, v34, v35
  v_min3_f32 v57, v57, v34, v35
  v_max3_f32 v58, v58, v36, v37
  v_min3_f32 v59, v59, v36, v37
  s_mov_b64 exec, 0xffff
  buffer_load_dwordx4 v[116:119], v80, s[24:27], s86 offen sc1
  s_mov_b64 exec, -1
  v_max3_f32 v56, v56, v38, v39
  v_min3_f32 v57, v57, v38, v39
  v_max_f32 v56, v56, v58
  v_min_f32 v57, v57, v59
  v_pk_mul_f32 v[56:57], v[56:57], s[90:91] neg_lo:[0,1]
  v_pk_fma_f32 v[40:41], v[24:25], s[90:91], v[56:57] op_sel:[0,0,1] op_sel_hi:[1,1,1] neg_lo:[1,0,0] neg_hi:[1,0,0]
  v_pk_fma_f32 v[24:25], v[24:25], s[90:91], v[56:57] op_sel:[0,0,0] op_sel_hi:[1,1,0]
  v_pk_fma_f32 v[42:43], v[26:27], s[90:91], v[56:57] op_sel:[0,0,1] op_sel_hi:[1,1,1] neg_lo:[1,0,0] neg_hi:[1,0,0]
  v_pk_fma_f32 v[26:27], v[26:27], s[90:91], v[56:57] op_sel:[0,0,0] op_sel_hi:[1,1,0]
  v_pk_fma_f32 v[44:45], v[28:29], s[90:91], v[56:57] op_sel:[0,0,1] op_sel_hi:[1,1,1] neg_lo:[1,0,0] neg_hi:[1,0,0]
  v_pk_fma_f32 v[28:29], v[28:29], s[90:91], v[56:57] op_sel:[0,0,0] op_sel_hi:[1,1,0]
  v_pk_fma_f32 v[46:47], v[30:31], s[90:91], v[56:57] op_sel:[0,0,1] op_sel_hi:[1,1,1] neg_lo:[1,0,0] neg_hi:[1,0,0]
  v_pk_fma_f32 v[30:31], v[30:31], s[90:91], v[56:57] op_sel:[0,0,0] op_sel_hi:[1,1,0]
  v_pk_fma_f32 v[48:49], v[32:33], s[90:91], v[56:57] op_sel:[0,0,1] op_sel_hi:[1,1,1] neg_lo:[1,0,0] neg_hi:[1,0,0]
  v_pk_fma_f32 v[32:33], v[32:33], s[90:91], v[56:57] op_sel:[0,0,0] op_sel_hi:[1,1,0]
  v_pk_fma_f32 v[50:51], v[34:35], s[90:91], v[56:57] op_sel:[0,0,1] op_sel_hi:[1,1,1] neg_lo:[1,0,0] neg_hi:[1,0,0]
  v_pk_fma_f32 v[34:35], v[34:35], s[90:91], v[56:57] op_sel:[0,0,0] op_sel_hi:[1,1,0]
  v_pk_fma_f32 v[52:53], v[36:37], s[90:91], v[56:57] op_sel:[0,0,1] op_sel_hi:[1,1,1] neg_lo:[1,0,0] neg_hi:[1,0,0]
  v_pk_fma_f32 v[36:37], v[36:37], s[90:91], v[56:57] op_sel:[0,0,0] op_sel_hi:[1,1,0]
  v_pk_fma_f32 v[54:55], v[38:39], s[90:91], v[56:57] op_sel:[0,0,1] op_sel_hi:[1,1,1] neg_lo:[1,0,0] neg_hi:[1,0,0]
  v_pk_fma_f32 v[38:39], v[38:39], s[90:91], v[56:57] op_sel:[0,0,0] op_sel_hi:[1,1,0]
  v_exp_f32 v24, v24
  v_exp_f32 v40, v40
  v_exp_f32 v25, v25
  v_exp_f32 v41, v41
  v_exp_f32 v26, v26
  v_exp_f32 v42, v42
  v_exp_f32 v27, v27
  v_exp_f32 v43, v43
  v_exp_f32 v28, v28
  v_exp_f32 v44, v44
  v_exp_f32 v29, v29
  v_exp_f32 v45, v45
  v_exp_f32 v30, v30
  v_exp_f32 v46, v46
  v_exp_f32 v31, v31
  v_exp_f32 v47, v47
  v_exp_f32 v32, v32
  v_exp_f32 v48, v48
  v_exp_f32 v33, v33
  v_exp_f32 v49, v49
  v_exp_f32 v34, v34
  v_exp_f32 v50, v50
  v_exp_f32 v35, v35
  v_exp_f32 v51, v51
  v_exp_f32 v36, v36
  v_exp_f32 v52, v52
  v_exp_f32 v37, v37
  v_exp_f32 v53, v53
  v_exp_f32 v38, v38
  v_exp_f32 v54, v54
  v_exp_f32 v39, v39
  v_exp_f32 v55, v55
  v_pk_add_f32 v[64:65], v[24:25], v[26:27]
  v_pk_add_f32 v[68:69], v[40:41], v[42:43]
  v_pk_add_f32 v[66:67], v[28:29], v[30:31]
  v_pk_add_f32 v[70:71], v[44:45], v[46:47]
  v_pk_add_f32 v[64:65], v[64:65], v[32:33]
  v_pk_add_f32 v[68:69], v[68:69], v[48:49]
  v_pk_add_f32 v[66:67], v[66:67], v[34:35]
  v_pk_add_f32 v[70:71], v[70:71], v[50:51]
  v_pk_add_f32 v[64:65], v[64:65], v[36:37]
  v_pk_add_f32 v[68:69], v[68:69], v[52:53]
  v_pk_add_f32 v[66:67], v[66:67], v[38:39]
  s_waitcnt vmcnt(0)
  v_and_b32 v116, v116, v117
  v_and_b32 v118, v118, v119
  v_and_b32 v116, v116, v118
  v_cmp_eq_u32 vcc, 1, v116
  s_nop 1
  s_and_b32 s79, vcc_lo, 0xffff
  s_cmp_eq_u32 s79, 0xffff
  s_cselect_b32 s75, 1, 0
  s_cbranch_scc0 G_k2
  buffer_load_dwordx4 v[100:103], v5, s[24:27], s82 offen offset:0 sc1
  buffer_load_dwordx4 v[104:107], v5, s[24:27], s82 offen offset:1024 sc1
  buffer_load_dwordx4 v[108:111], v5, s[24:27], s82 offen offset:2048 sc1
  buffer_load_dwordx4 v[112:115], v5, s[24:27], s82 offen offset:3072 sc1
  s_mov_b64 exec, 0xffff
  buffer_load_dwordx4 v[116:119], v5, s[24:27], s83 offen sc1
  s_mov_b64 exec, -1
  s_branch G_k2e
G_k2:
  s_mov_b64 exec, 0xffff
  buffer_load_dwordx4 v[116:119], v80, s[24:27], s86 offen sc1
  s_mov_b64 exec, -1
G_k2e:
  v_pk_add_f32 v[70:71], v[70:71], v[54:55]
  v_pk_add_f32 v[64:65], v[64:65], v[66:67]
  v_pk_add_f32 v[68:69], v[68:69], v[70:71]
  v_add_f32 v60, v64, v65
  v_add_f32 v61, v68, v69
  v_rcp_f32 v60, v60
  v_rcp_f32 v61, v61
  s_nop 0
  v_pk_mul_f32 v[24:25], v[24:25], v[60:61] op_sel:[0,0] op_sel_hi:[1,0]
  v_pk_mul_f32 v[40:41], v[40:41], v[60:61] op_sel:[0,1] op_sel_hi:[1,1]
  v_pk_mul_f32 v[26:27], v[26:27], v[60:61] op_sel:[0,0] op_sel_hi:[1,0]
  v_pk_mul_f32 v[42:43], v[42:43], v[60:61] op_sel:[0,1] op_sel_hi:[1,1]
  v_pk_mul_f32 v[28:29], v[28:29], v[60:61] op_sel:[0,0] op_sel_hi:[1,0]
  v_pk_mul_f32 v[44:45], v[44:45], v[60:61] op_sel:[0,1] op_sel_hi:[1,1]
  v_pk_mul_f32 v[30:31], v[30:31], v[60:61] op_sel:[0,0] op_sel_hi:[1,0]
  v_pk_mul_f32 v[46:47], v[46:47], v[60:61] op_sel:[0,1] op_sel_hi:[1,1]
  v_pk_mul_f32 v[32:33], v[32:33], v[60:61] op_sel:[0,0] op_sel_hi:[1,0]
  v_pk_mul_f32 v[48:49], v[48:49], v[60:61] op_sel:[0,1] op_sel_hi:[1,1]
  v_pk_mul_f32 v[34:35], v[34:35], v[60:61] op_sel:[0,0] op_sel_hi:[1,0]
  v_pk_mul_f32 v[50:51], v[50:51], v[60:61] op_sel:[0,1] op_sel_hi:[1,1]
  v_pk_mul_f32 v[36:37], v[36:37], v[60:61] op_sel:[0,0] op_sel_hi:[1,0]
  v_pk_mul_f32 v[52:53], v[52:53], v[60:61] op_sel:[0,1] op_sel_hi:[1,1]
  v_pk_mul_f32 v[38:39], v[38:39], v[60:61] op_sel:[0,0] op_sel_hi:[1,0]
  v_pk_mul_f32 v[54:55], v[54:55], v[60:61] op_sel:[0,1] op_sel_hi:[1,1]
  v_cvt_pk_bf16_f32 v64, v24, v25
  v_cvt_pk_bf16_f32 v65, v26, v27
  v_cvt_pk_bf16_f32 v66, v28, v29
  v_cvt_pk_bf16_f32 v67, v30, v31
  v_cvt_pk_bf16_f32 v68, v32, v33
  v_cvt_pk_bf16_f32 v69, v34, v35
  v_cvt_pk_bf16_f32 v70, v36, v37
  v_cvt_pk_bf16_f32 v71, v38, v39
  v_cvt_pk_bf16_f32 v72, v40, v41
  s_cmp_eq_u32 s75, 1
  s_cbranch_scc1 G_k0
  s_waitcnt vmcnt(0)
  v_and_b32 v116, v116, v117
  v_and_b32 v118, v118, v119
  v_and_b32 v116, v116, v118
  v_cmp_eq_u32 vcc, 1, v116
  s_nop 1
  s_and_b32 s79, vcc_lo, 0xffff
  s_cmp_eq_u32 s79, 0xffff
  s_cselect_b32 s75, 1, 0
  s_cbranch_scc0 G_k3
  buffer_load_dwordx4 v[100:103], v5, s[24:27], s82 offen offset:0 sc1
  buffer_load_dwordx4 v[104:107], v5, s[24:27], s82 offen offset:1024 sc1
  buffer_load_dwordx4 v[108:111], v5, s[24:27], s82 offen offset:2048 sc1
  buffer_load_dwordx4 v[112:115], v5, s[24:27], s82 offen offset:3072 sc1
  s_mov_b64 exec, 0xffff
  buffer_load_dwordx4 v[116:119], v5, s[24:27], s83 offen sc1
  s_mov_b64 exec, -1
G_k3:
G_k0:
  v_cvt_pk_bf16_f32 v73, v42, v43
  v_cvt_pk_bf16_f32 v74, v44, v45
  v_cvt_pk_bf16_f32 v75, v46, v47
  v_cvt_pk_bf16_f32 v76, v48, v49
  v_cvt_pk_bf16_f32 v77, v50, v51
  v_cvt_pk_bf16_f32 v78, v52, v53
  v_cvt_pk_bf16_f32 v79, v54, v55
  s_cmp_eq_u32 s75, 1
  s_cbranch_scc1 G_k1
  s_mov_b32 s78, 0
G_pk_a:
  s_mov_b64 exec, 0xffff
  buffer_load_dwordx4 v[116:119], v80, s[24:27], s86 offen sc1
  s_mov_b64 exec, -1
  s_add_u32 s78, s78, 1
  s_cmp_ge_u32 s78, 65536
  s_cbranch_scc1 K_end
  s_waitcnt vmcnt(0)
  v_and_b32 v116, v116, v117
  v_and_b32 v118, v118, v119
  v_and_b32 v116, v116, v118
  v_cmp_eq_u32 vcc, 1, v116
  s_nop 1
  s_and_b32 s79, vcc_lo, 0xffff
  s_cmp_eq_u32 s79, 0xffff
  s_cbranch_scc1 G_pk_b
  s_sleep 2
  s_branch G_pk_a
G_pk_b:
  buffer_load_dwordx4 v[100:103], v5, s[24:27], s82 offen offset:0 sc1
  buffer_load_dwordx4 v[104:107], v5, s[24:27], s82 offen offset:1024 sc1
  buffer_load_dwordx4 v[108:111], v5, s[24:27], s82 offen offset:2048 sc1
  buffer_load_dwordx4 v[112:115], v5, s[24:27], s82 offen offset:3072 sc1
  s_mov_b64 exec, 0xffff
  buffer_load_dwordx4 v[116:119], v5, s[24:27], s83 offen sc1
  s_mov_b64 exec, -1
G_k1:
  s_waitcnt vmcnt(4)
  v_cvt_pk_bf16_f32 v152, v100, v101
  v_cvt_pk_bf16_f32 v153, v102, v103
  ds_write_b64 v86, v[152:153] offset:0
  s_waitcnt vmcnt(3)
  v_cvt_pk_bf16_f32 v154, v104, v105
  v_cvt_pk_bf16_f32 v155, v106, v107
  ds_write_b64 v86, v[154:155] offset:512
  s_waitcnt vmcnt(2)
  v_cvt_pk_bf16_f32 v156, v108, v109
  v_cvt_pk_bf16_f32 v157, v110, v111
  ds_write_b64 v86, v[156:157] offset:1024
  s_waitcnt vmcnt(1)
  v_cvt_pk_bf16_f32 v158, v112, v113
  v_cvt_pk_bf16_f32 v159, v114, v115
  ds_write_b64 v86, v[158:159] offset:1536
  s_waitcnt vmcnt(0)
  v_cvt_pk_bf16_f32 v160, v116, v117
  v_cvt_pk_bf16_f32 v161, v118, v119
  s_mov_b64 exec, 0xffff
  ds_write_b64 v86, v[160:161] offset:2048
  s_mov_b64 exec, -1
  ds_read_b128 v[120:123], v87 offset:0
  ds_read_b128 v[124:127], v87 offset:16
  ds_read_b128 v[128:131], v87 offset:32
  ds_read_b128 v[132:135], v87 offset:48
  ds_read_b128 v[136:139], v88 offset:2048
  ds_read_b128 v[140:143], v88 offset:2064
  ds_read_b128 v[144:147], v88 offset:2080
  ds_read_b128 v[148:151], v88 offset:2096
  s_waitcnt lgkmcnt(7)
  v_mfma_f32_32x32x16_bf16 v[152:167], v[120:123], v[64:67], 0
  s_waitcnt lgkmcnt(6)
  v_mfma_f32_32x32x16_bf16 v[152:167], v[124:127], v[68:71], v[152:167]
  s_waitcnt lgkmcnt(5)
  v_mfma_f32_32x32x16_bf16 v[152:167], v[128:131], v[72:75], v[152:167]
  s_waitcnt lgkmcnt(4)
  v_mfma_f32_32x32x16_bf16 v[152:167], v[132:135], v[76:79], v[152:167]
  s_waitcnt lgkmcnt(0)
  v_dot2_f32_bf16 v252, v64, v136, v252
  v_dot2_f32_bf16 v253, v65, v137, v253
  v_dot2_f32_bf16 v252, v66, v138, v252
  v_dot2_f32_bf16 v253, v67, v139, v253
  v_dot2_f32_bf16 v252, v68, v140, v252
  v_dot2_f32_bf16 v253, v69, v141, v253
  v_dot2_f32_bf16 v252, v70, v142, v252
  v_dot2_f32_bf16 v253, v71, v143, v253
  v_dot2_f32_bf16 v252, v72, v144, v252
  v_dot2_f32_bf16 v253, v73, v145, v253
  v_dot2_f32_bf16 v252, v74, v146, v252
  v_dot2_f32_bf16 v253, v75, v147, v253
  v_dot2_f32_bf16 v252, v76, v148, v252
  v_dot2_f32_bf16 v253, v77, v149, v253
  v_dot2_f32_bf16 v252, v78, v150, v252
  v_dot2_f32_bf16 v253, v79, v151, v253
  s_nop 2
  v_add_f32 v252, v252, v253
  v_add_f32 v252, 0x358637bd, v252
  v_rcp_f32 v252, v252
  s_nop 0
  v_pk_mul_f32 v[152:153], v[152:153], v[252:253] op_sel:[0,0] op_sel_hi:[1,0]
  v_pk_mul_f32 v[154:155], v[154:155], v[252:253] op_sel:[0,0] op_sel_hi:[1,0]
  v_pk_mul_f32 v[156:157], v[156:157], v[252:253] op_sel:[0,0] op_sel_hi:[1,0]
  v_pk_mul_f32 v[158:159], v[158:159], v[252:253] op_sel:[0,0] op_sel_hi:[1,0]
  v_pk_mul_f32 v[160:161], v[160:161], v[252:253] op_sel:[0,0] op_sel_hi:[1,0]
  v_pk_mul_f32 v[162:163], v[162:163], v[252:253] op_sel:[0,0] op_sel_hi:[1,0]
  v_pk_mul_f32 v[164:165], v[164:165], v[252:253] op_sel:[0,0] op_sel_hi:[1,0]
  v_pk_mul_f32 v[166:167], v[166:167], v[252:253] op_sel:[0,0] op_sel_hi:[1,0]
  v_cvt_pk_bf16_f32 v120, v152, v153
  v_cvt_pk_bf16_f32 v121, v154, v155
  v_cvt_pk_bf16_f32 v122, v156, v157
  v_cvt_pk_bf16_f32 v123, v158, v159
  v_cvt_pk_bf16_f32 v124, v160, v161
  v_cvt_pk_bf16_f32 v125, v162, v163
  v_cvt_pk_bf16_f32 v126, v164, v165
  v_cvt_pk_bf16_f32 v127, v166, v167
  buffer_store_dwordx4 v[120:123], v7, s[20:23], s84 offen offset:0 sc1
  buffer_store_dwordx4 v[124:127], v7, s[20:23], s84 offen offset:512 sc1
  s_setprio 0
  s_waitcnt vmcnt(0)
  s_barrier
  s_cmp_lg_u32 s72, 1
  s_cbranch_scc1 G_nosig
  v_mov_b32 v4, 1
  s_mov_b64 exec, 1
  buffer_store_dword v4, off, s[24:27], s3 sc1
  s_mov_b64 exec, -1
G_nosig:
  s_cmp_lt_u32 s72, 4
  s_cbranch_scc1 K_final
  v_dot2_f32_bf16 v240, v200, v232, 0
  v_dot2_f32_bf16 v244, v216, v232, 0
  v_dot2_f32_bf16 v240, v201, v233, v240
  v_dot2_f32_bf16 v244, v217, v233, v244
  v_dot2_f32_bf16 v240, v202, v234, v240
  v_dot2_f32_bf16 v244, v218, v234, v244
  v_dot2_f32_bf16 v240, v203, v235, v240
  v_dot2_f32_bf16 v244, v219, v235, v244
  v_dot2_f32_bf16 v241, v204, v232, 0
  v_dot2_f32_bf16 v245, v220, v232, 0
  v_dot2_f32_bf16 v241, v205, v233, v241
  v_dot2_f32_bf16 v245, v221, v233, v245
  v_dot2_f32_bf16 v241, v206, v234, v241
  v_dot2_f32_bf16 v245, v222, v234, v245
  v_dot2_f32_bf16 v241, v207, v235, v241
  v_dot2_f32_bf16 v245, v223, v235, v245
  v_dot2_f32_bf16 v242, v208, v232, 0
  v_dot2_f32_bf16 v246, v224, v232, 0
  v_dot2_f32_bf16 v242, v209, v233, v242
  v_dot2_f32_bf16 v246, v225, v233, v246
  v_dot2_f32_bf16 v242, v210, v234, v242
  v_dot2_f32_bf16 v246, v226, v234, v246
  v_dot2_f32_bf16 v242, v211, v235, v242
  v_dot2_f32_bf16 v246, v227, v235, v246
  v_dot2_f32_bf16 v243, v212, v232, 0
  v_dot2_f32_bf16 v247, v228, v232, 0
  v_dot2_f32_bf16 v243, v213, v233, v243
  v_dot2_f32_bf16 v247, v229, v233, v247
  v_dot2_f32_bf16 v243, v214, v234, v243
  v_dot2_f32_bf16 v247, v230, v234, v247
  v_dot2_f32_bf16 v243, v215, v235, v243
  v_dot2_f32_bf16 v247, v231, v235, v247
  v_permlane32_swap_b32 v240, v241
  v_permlane32_swap_b32 v244, v245
  v_permlane32_swap_b32 v242, v243
  v_permlane32_swap_b32 v246, v247
  v_add_f32 v240, v240, v241
  v_add_f32 v244, v244, v245
  v_add_f32 v242, v242, v243
  v_add_f32 v246, v246, v247
  s_nop 0
  v_permlane16_swap_b32 v240, v242
  v_permlane16_swap_b32 v244, v246
  v_add_f32 v240, v240, v242
  v_add_f32 v244, v244, v246
  s_nop 0
  v_add_f32_dpp v240, v240, v240 row_ror:8 row_mask:0xf bank_mask:0xf
  v_add_f32_dpp v244, v244, v244 row_ror:8 row_mask:0xf bank_mask:0xf
  s_nop 0
  v_add_f32_dpp v240, v240, v240 row_ror:4 row_mask:0xf bank_mask:0xf
  v_add_f32_dpp v244, v244, v244 row_ror:4 row_mask:0xf bank_mask:0xf
  s_nop 0
  v_add_f32_dpp v240, v240, v240 row_ror:2 row_mask:0xf bank_mask:0xf
  v_add_f32_dpp v244, v244, v244 row_ror:2 row_mask:0xf bank_mask:0xf
  s_nop 0
  v_add_f32_dpp v240, v240, v240 row_ror:1 row_mask:0xf bank_mask:0xf
  v_add_f32_dpp v244, v244, v244 row_ror:1 row_mask:0xf bank_mask:0xf
  v_cvt_pk_bf16_f32 v240, v240, v240
  v_cvt_pk_bf16_f32 v244, v244, v244
  v_and_b32 v240, 0xffff0000, v240
  v_and_b32 v244, 0xffff0000, v244
  v_mul_f32 v240, 0xbfb8aa3b, v240
  v_mul_f32 v244, 0xbfb8aa3b, v244
  v_exp_f32 v240, v240
  v_exp_f32 v244, v244
  v_add_f32 v240, 1.0, v240
  v_add_f32 v244, 1.0, v244
  v_rcp_f32 v240, v240
  v_rcp_f32 v244, v244
  v_cvt_pk_bf16_f32 v240, v240, v240
  v_cvt_pk_bf16_f32 v244, v244, v244
  v_and_b32 v250, 0xffff0000, v240
  v_and_b32 v251, 0xffff0000, v244
  s_branch K_final
K_conv:
  s_sub_u32 s71, s71, 16
  v_lshrrev_b32 v2, 6, v0
  v_and_b32 v1, 63, v0
  v_readfirstlane_b32 s72, v2
  s_lshl_b32 s73, s70, 4
  s_add_u32 s73, s73, s71
  v_lshlrev_b32 v2, 1, v0
  s_lshl_b32 s76, s73, 3
  s_lshl_b32 s77, s73, 10
  s_waitcnt lgkmcnt(0)
  s_load_dwordx2 s[80:81], s[58:59], s76
  s_load_dwordx2 s[82:83], s[60:61], s76
  s_mov_b32 s12, s46
  s_mov_b32 s13, s47
  s_mov_b32 s14, 0x20000
  s_mov_b32 s15, 0x20000
  buffer_load_ushort v38, v2, s[12:15], s77 offen
  s_mov_b32 s16, s48
  s_mov_b32 s17, s49
  s_mov_b32 s18, 0x20000
  s_mov_b32 s19, 0x20000
  buffer_load_ushort v39, v2, s[16:19], s77 offen
  s_mov_b32 s20, s50
  s_mov_b32 s21, s51
  s_mov_b32 s22, 0x20000
  s_mov_b32 s23, 0x20000
  buffer_load_ushort v40, v2, s[20:23], s77 offen
  s_mov_b32 s24, s52
  s_mov_b32 s25, s53
  s_mov_b32 s26, 0x20000
  s_mov_b32 s27, 0x20000
  buffer_load_ushort v41, v2, s[24:27], s77 offen
  s_mov_b32 s28, s54
  s_mov_b32 s29, s55
  s_mov_b32 s30, 0x20000
  s_mov_b32 s31, 0x20000
  buffer_load_ushort v42, v2, s[28:31], s77 offen
  s_mov_b32 s32, s56
  s_mov_b32 s33, s57
  s_mov_b32 s34, 0x20000
  s_mov_b32 s35, 0x20000
  buffer_load_ushort v43, v2, s[32:35], s77 offen
  s_mov_b32 s4, s36
  s_mov_b32 s5, s37
  s_mov_b32 s6, 0x200000
  s_mov_b32 s7, 0x20000
  s_lshr_b32 s74, s72, 1
  s_and_b32 s75, s72, 1
  v_lshlrev_b32 v36, 10, v0
  v_add_u32 v36, s76, v36
  v_add_u32 v37, -3072, v36
  s_barrier
  s_mov_b32 s8, s38
  s_mov_b32 s9, s39
  s_mov_b32 s10, 0x180000
  s_mov_b32 s11, 0x20000
  s_movk_i32 s78, 255
  s_bitcmp0_b32 s78, s72
  s_cbranch_scc1 C_paee
  s_cmp_eq_u32 s72, 7
  s_cbranch_scc1 C_pa2e
  s_lshl_b32 s78, s72, 4
  s_add_u32 s78, s78, s71
  s_lshr_b32 s85, s78, 4
  s_add_u32 s85, s85, 1
  s_and_b32 s86, s78, 7
  s_bitcmp1_b32 s78, 3
  s_cbranch_scc1 Ce_pfw
  s_lshr_b32 s87, s70, 1
  s_lshl_b32 s87, s87, 19
  s_lshl_b32 s86, s86, 16
  s_add_u32 s87, s87, s86
  s_lshl_b32 s85, s85, 7
  s_add_u32 s87, s87, s85
  v_lshlrev_b32 v5, 10, v1
  buffer_load_dword v10, v5, s[4:7], s87 offen
  s_branch Ce_pfd
Ce_pfw:
  s_lshl_b32 s85, s85, 3
  s_add_u32 s85, s85, s86
  s_mul_i32 s85, s85, 24576
  s_and_b32 s86, s70, 1
  s_lshl_b32 s86, s86, 9
  s_add_u32 s85, s85, s86
  v_lshrrev_b32 v5, 3, v1
  s_movk_i32 s86, 3072
  v_mul_u32_u24 v5, s86, v5
  v_bfe_u32 v10, v1, 2, 1
  v_lshl_add_u32 v5, v10, 10, v5
  v_and_b32 v10, 3, v1
  v_lshl_add_u32 v5, v10, 7, v5
  buffer_load_dword v10, v5, s[8:11], s85 offen offset:1024
Ce_pfd:
  s_branch C_paee
C_pa2e:
  s_getpc_b64 s[90:91]
CPF_pc:
  s_sub_u32 s90, s90, CPF_pc-gated_mix__linear_kernel_hedgehog__ssm_conv_s4__prompt_kernel
  s_subb_u32 s91, s91, 0
  s_lshl_b32 s92, s71, 13
  v_lshl_add_u32 v30, v1, 7, s92
  v_min_u32 v30, K_end-gated_mix__linear_kernel_hedgehog__ssm_conv_s4__prompt_kernel, v30
  v_mov_b32 v29, s91
  v_add_co_u32 v28, vcc, s90, v30
  s_nop 1
  v_addc_co_u32 v29, vcc, 0, v29, vcc
  global_load_dword v10, v[28:29], off
C_paee:
  s_mov_b32 s8, s38
  s_mov_b32 s9, s39
  s_mov_b32 s10, 0x180000
  s_mov_b32 s11, 0x20000
  s_cmp_ge_u32 s72, 4
  s_cbranch_scc1 C_pbe
  s_lshl_b32 s78, s72, 4
  s_add_u32 s78, s78, s71
  s_cmp_ge_u32 s72, 2
  s_cbranch_scc1 C_pb2
  s_lshl_b32 s78, s78, 16
  s_lshl_b32 s79, s70, 7
  s_add_u32 s78, s78, s79
  v_lshlrev_b32 v5, 10, v1
  buffer_load_dword v11, v5, s[4:7], s78 offen
  s_branch C_pbe
C_pb2:
  s_sub_u32 s78, s78, 32
  s_mul_i32 s78, s78, 49152
  s_and_b32 s79, s70, 1
  s_lshl_b32 s79, s79, 9
  s_add_u32 s78, s78, s79
  s_movk_i32 s86, 3072
  v_and_b32 v4, 3, v1
  v_lshlrev_b32 v4, 7, v4
  v_lshrrev_b32 v5, 2, v1
  v_mad_u32_u24 v5, v5, s86, v4
  buffer_load_dword v11, v5, s[8:11], s78 offen
C_pbe:
  s_add_u32 s8, s68, 0x400000
  s_addc_u32 s9, s69, 0
  s_mov_b32 s10, 0x200000
  s_mov_b32 s11, 0x20000
  s_mul_i32 s84, s72, 8704
  s_add_u32 s84, s84, 90112
  v_lshrrev_b32 v2, 3, v1
  s_movk_i32 s76, 528
  v_mul_u32_u24 v6, s76, v2
  v_bfe_u32 v2, v1, 2, 1
  v_lshl_add_u32 v6, v2, 8, v6
  v_and_b32 v2, 3, v1
  v_lshl_add_u32 v6, v2, 2, v6
  v_add_u32 v6, s84, v6
  s_mul_i32 s76, s72, 2176
  s_add_u32 s76, s76, 68480
  v_lshl_add_u32 v7, v1, 3, s76
  v_and_b32 v4, 3, v1
  v_lshrrev_b32 v3, 4, v1
  v_lshl_add_u32 v5, v3, 2, v4
  v_bfe_u32 v2, v1, 2, 2
  v_lshl_add_u32 v5, v5, 2, v2
  v_lshl_add_u32 v8, v5, 3, s76
  s_movk_i32 s76, 17120
  v_mul_u32_u24 v9, s76, v4
  v_lshrrev_b32 v2, 2, v1
  v_lshl_add_u32 v9, v2, 3, v9
  s_lshl_b32 s76, s72, 7
  s_add_u32 s76, s76, 56
  v_add_u32 v9, s76, v9
  s_waitcnt lgkmcnt(0)
  s_bitcmp1_b32 s74, 1
  s_cselect_b32 s80, s81, s80
  s_cselect_b32 s82, s83, s82
  s_lshl_b32 s81, s80, 16
  s_lshl_b32 s83, s82, 16
  s_and_b32 s80, s80, 0xffff0000
  s_and_b32 s82, s82, 0xffff0000
  s_bitcmp1_b32 s74, 0
  s_cselect_b32 s80, s80, s81
  s_cselect_b32 s82, s82, s83
  s_cmp_eq_u32 s75, 0
  s_cselect_b32 s82, s82, 0
  v_mov_b32 v44, s80
  v_mul_f32 v44, 0x3fb8aa3b, v44
  v_exp_f32 v44, v44
  v_mov_b32 v45, 0
  v_writelane_b32 v45, s82, 0
  v_cvt_pk_bf16_f32 v44, v44, v44
  v_and_b32 v44, 0xffff0000, v44
  s_cmp_lg_u32 s72, 0
  s_cbranch_scc1 C_nozp
  v_mov_b32 v28, 0
  v_mov_b32 v29, 0
  v_mov_b32 v30, 0
  v_mov_b32 v31, 0
  s_movk_i32 s76, 17120
  v_mul_u32_u24 v2, s76, v3
  v_bfe_u32 v5, v1, 2, 2
  s_movk_i32 s76, 4272
  v_mad_u32_u24 v2, v5, s76, v2
  v_lshl_add_u32 v2, v4, 4, v2
  ds_write_b128 v2, v[28:31] offset:0
C_nozp:
  v_and_b32 v2, 15, v1
  v_lshrrev_b32 v5, 5, v1
  s_movk_i32 s76, 528
  v_mul_u32_u24 v46, s76, v5
  v_and_b32 v5, 1, v3
  v_lshl_add_u32 v46, v5, 8, v46
  v_lshl_add_u32 v46, v2, 4, v46
  v_add_u32 v46, s84, v46
  s_mov_b32 s88, s70
  s_mov_b32 s89, s71
  s_movk_i32 s76, 15
  s_bitcmp1_b32 s76, s72
  s_cbranch_scc1 C_w2
  s_movk_i32 s76, 240
  s_bitcmp1_b32 s76, s72
  s_cbranch_scc1 C_w1
  s_waitcnt vmcnt(0)
  s_branch C_w0
C_w2:
  s_waitcnt vmcnt(2)
  s_branch C_w0
C_w1:
  s_waitcnt vmcnt(1)
C_w0:
  s_add_u32 s8, s68, 0x400000
  s_addc_u32 s9, s69, 0
  s_mov_b32 s10, 0x200000
  s_mov_b32 s11, 0x20000
  s_and_b32 s87, s72, 3
  v_lshlrev_b32 v38, 16, v38
  v_lshlrev_b32 v39, 16, v39
  v_lshlrev_b32 v40, 16, v40
  v_lshlrev_b32 v41, 16, v41
  v_lshlrev_b32 v42, 16, v42
  v_lshlrev_b32 v43, 16, v43
  v_mul_f32 v47, v44, v38
  v_mul_f32 v48, v44, v39
  v_mul_f32 v47, 0x3fb8aa3b, v47
  v_mul_f32 v48, 0x3e22f983, v48
  v_mul_f32 v90, 0x41000000, v47
  v_mul_f32 v92, 1.0, v47
  v_mul_f32 v94, 0x43000000, v47
  v_pk_mul_f32 v[40:41], v[40:41], v[44:45] op_sel:[0,0] op_sel_hi:[1,0]
  v_mul_f32 v91, 0x41000000, v48
  v_mul_f32 v93, 1.0, v48
  v_mul_f32 v95, 0x43000000, v48
  v_pk_mul_f32 v[72:73], v[42:43], v[40:41] op_sel:[0,0] op_sel_hi:[0,1]
  v_exp_f32 v90, v90
  v_exp_f32 v92, v92
  v_exp_f32 v94, v94
  v_pk_fma_f32 v[72:73], v[42:43], v[40:41], v[72:73] op_sel:[1,1,0] op_sel_hi:[1,0,1] neg_lo:[0,1,0]
  v_fract_f32 v91, v91
  v_fract_f32 v93, v93
  v_fract_f32 v95, v95
  v_xor_b32 v73, 0x80000000, v73
  v_cos_f32 v64, v91
  v_cos_f32 v50, v93
  v_cos_f32 v70, v95
  v_sin_f32 v65, v91
  v_sin_f32 v51, v93
  v_sin_f32 v71, v95
  v_pk_mul_f32 v[64:65], v[64:65], v[90:91] op_sel:[0,0] op_sel_hi:[1,0]
  v_pk_mul_f32 v[50:51], v[50:51], v[92:93] op_sel:[0,0] op_sel_hi:[1,0]
  v_pk_mul_f32 v[70:71], v[70:71], v[94:95] op_sel:[0,0] op_sel_hi:[1,0]
  v_xor_b32 v65, 0x80000000, v65
  v_mov_b32 v87, 0x3f80
  v_cvt_pk_bf16_f32 v88, v72, v73
  ds_write_b32 v6, v87 offset:4352
  ds_write_b32 v6, v88 offset:0
  v_cvt_pk_bf16_f32 v84, v50, v51
  v_pk_mul_f32 v[74:75], v[72:73], v[64:65] op_sel:[0,0] op_sel_hi:[0,1]
  ds_write_b32 v6, v84 offset:4368
  v_pk_fma_f32 v[74:75], v[72:73], v[64:65], v[74:75] op_sel:[1,1,0] op_sel_hi:[1,0,1] neg_lo:[0,1,0]
  v_cvt_pk_bf16_f32 v85, v70, v71
  v_cvt_pk_bf16_f32 v89, v74, v75
  ds_write_b32 v6, v85 offset:4480
  ds_write_b32 v6, v89 offset:16
  v_pk_mul_f32 v[52:53], v[50:51], v[50:51] op_sel:[0,0] op_sel_hi:[0,1]
  v_pk_mul_f32 v[72:73], v[74:75], v[64:65] op_sel:[0,0] op_sel_hi:[0,1]
  v_pk_fma_f32 v[52:53], v[50:51], v[50:51], v[52:53] op_sel:[1,1,0] op_sel_hi:[1,0,1] neg_lo:[0,1,0]
  v_pk_fma_f32 v[72:73], v[74:75], v[64:65], v[72:73] op_sel:[1,1,0] op_sel_hi:[1,0,1] neg_lo:[0,1,0]
  v_pk_mul_f32 v[76:77], v[70:71], v[50:51] op_sel:[0,0] op_sel_hi:[0,1]
  v_cvt_pk_bf16_f32 v88, v72, v73
  v_pk_fma_f32 v[76:77], v[70:71], v[50:51], v[76:77] op_sel:[1,1,0] op_sel_hi:[1,0,1] neg_lo:[0,1,0]
  ds_write_b32 v6, v88 offset:32
  v_cvt_pk_bf16_f32 v86, v76, v77
  v_pk_mul_f32 v[74:75], v[72:73], v[64:65] op_sel:[0,0] op_sel_hi:[0,1]
  ds_write_b32 v6, v86 offset:4496
  v_pk_fma_f32 v[74:75], v[72:73], v[64:65], v[74:75] op_sel:[1,1,0] op_sel_hi:[1,0,1] neg_lo:[0,1,0]
  v_cvt_pk_bf16_f32 v87, v52, v53
  v_cvt_pk_bf16_f32 v89, v74, v75
  ds_write_b32 v6, v87 offset:4384
  ds_write_b32 v6, v89 offset:48
  v_pk_mul_f32 v[54:55], v[52:53], v[50:51] op_sel:[0,0] op_sel_hi:[0,1]
  v_pk_mul_f32 v[72:73], v[74:75], v[64:65] op_sel:[0,0] op_sel_hi:[0,1]
  v_pk_fma_f32 v[54:55], v[52:53], v[50:51], v[54:55] op_sel:[1,1,0] op_sel_hi:[1,0,1] neg_lo:[0,1,0]
  v_pk_fma_f32 v[72:73], v[74:75], v[64:65], v[72:73] op_sel:[1,1,0] op_sel_hi:[1,0,1] neg_lo:[0,1,0]
  v_pk_mul_f32 v[56:57], v[52:53], v[52:53] op_sel:[0,0] op_sel_hi:[0,1]
  v_cvt_pk_bf16_f32 v88, v72, v73
  v_pk_fma_f32 v[56:57], v[52:53], v[52:53], v[56:57] op_sel:[1,1,0] op_sel_hi:[1,0,1] neg_lo:[0,1,0]
  ds_write_b32 v6, v88 offset:64
  v_pk_mul_f32 v[78:79], v[70:71], v[52:53] op_sel:[0,0] op_sel_hi:[0,1]
  v_pk_mul_f32 v[74:75], v[72:73], v[64:65] op_sel:[0,0] op_sel_hi:[0,1]
  v_pk_fma_f32 v[78:79], v[70:71], v[52:53], v[78:79] op_sel:[1,1,0] op_sel_hi:[1,0,1] neg_lo:[0,1,0]
  v_pk_fma_f32 v[74:75], v[72:73], v[64:65], v[74:75] op_sel:[1,1,0] op_sel_hi:[1,0,1] neg_lo:[0,1,0]
  v_cvt_pk_bf16_f32 v84, v78, v79
  v_cvt_pk_bf16_f32 v89, v74, v75
  ds_write_b32 v6, v84 offset:4512
  ds_write_b32 v6, v89 offset:80
  v_cvt_pk_bf16_f32 v85, v54, v55
  v_pk_mul_f32 v[72:73], v[74:75], v[64:65] op_sel:[0,0] op_sel_hi:[0,1]
  ds_write_b32 v6, v85 offset:4400
  v_pk_fma_f32 v[72:73], v[74:75], v[64:65], v[72:73] op_sel:[1,1,0] op_sel_hi:[1,0,1] neg_lo:[0,1,0]
  v_cvt_pk_bf16_f32 v86, v56, v57
  v_cvt_pk_bf16_f32 v88, v72, v73
  ds_write_b32 v6, v86 offset:4416
  ds_write_b32 v6, v88 offset:96
  v_pk_mul_f32 v[58:59], v[56:57], v[50:51] op_sel:[0,0] op_sel_hi:[0,1]
  v_pk_mul_f32 v[74:75], v[72:73], v[64:65] op_sel:[0,0] op_sel_hi:[0,1]
  v_pk_fma_f32 v[58:59], v[56:57], v[50:51], v[58:59] op_sel:[1,1,0] op_sel_hi:[1,0,1] neg_lo:[0,1,0]
  v_pk_fma_f32 v[74:75], v[72:73], v[64:65], v[74:75] op_sel:[1,1,0] op_sel_hi:[1,0,1] neg_lo:[0,1,0]
  v_pk_mul_f32 v[60:61], v[56:57], v[52:53] op_sel:[0,0] op_sel_hi:[0,1]
  v_cvt_pk_bf16_f32 v89, v74, v75
  v_pk_fma_f32 v[60:61], v[56:57], v[52:53], v[60:61] op_sel:[1,1,0] op_sel_hi:[1,0,1] neg_lo:[0,1,0]
  ds_write_b32 v6, v89 offset:112
  v_pk_mul_f32 v[62:63], v[56:57], v[54:55] op_sel:[0,0] op_sel_hi:[0,1]
  v_pk_mul_f32 v[72:73], v[74:75], v[64:65] op_sel:[0,0] op_sel_hi:[0,1]
  v_pk_fma_f32 v[62:63], v[56:57], v[54:55], v[62:63] op_sel:[1,1,0] op_sel_hi:[1,0,1] neg_lo:[0,1,0]
  v_pk_fma_f32 v[72:73], v[74:75], v[64:65], v[72:73] op_sel:[1,1,0] op_sel_hi:[1,0,1] neg_lo:[0,1,0]
  v_cvt_pk_bf16_f32 v87, v58, v59
  v_cvt_pk_bf16_f32 v88, v72, v73
  ds_write_b32 v6, v87 offset:4432
  ds_write_b32 v6, v88 offset:128
  v_cvt_pk_bf16_f32 v84, v60, v61
  v_pk_mul_f32 v[74:75], v[72:73], v[64:65] op_sel:[0,0] op_sel_hi:[0,1]
  ds_write_b32 v6, v84 offset:4448
  v_pk_fma_f32 v[74:75], v[72:73], v[64:65], v[74:75] op_sel:[1,1,0] op_sel_hi:[1,0,1] neg_lo:[0,1,0]
  v_cvt_pk_bf16_f32 v85, v62, v63
  v_cvt_pk_bf16_f32 v89, v74, v75
  ds_write_b32 v6, v85 offset:4464
  ds_write_b32 v6, v89 offset:144
  v_pk_mul_f32 v[80:81], v[70:71], v[54:55] op_sel:[0,0] op_sel_hi:[0,1]
  v_pk_mul_f32 v[72:73], v[74:75], v[64:65] op_sel:[0,0] op_sel_hi:[0,1]
  v_pk_fma_f32 v[80:81], v[70:71], v[54:55], v[80:81] op_sel:[1,1,0] op_sel_hi:[1,0,1] neg_lo:[0,1,0]
  v_pk_fma_f32 v[72:73], v[74:75], v[64:65], v[72:73] op_sel:[1,1,0] op_sel_hi:[1,0,1] neg_lo:[0,1,0]
  v_cvt_pk_bf16_f32 v86, v80, v81
  v_cvt_pk_bf16_f32 v88, v72, v73
  ds_write_b32 v6, v86 offset:4528
  ds_write_b32 v6, v88 offset:160
  v_pk_mul_f32 v[82:83], v[70:71], v[56:57] op_sel:[0,0] op_sel_hi:[0,1]
  v_pk_mul_f32 v[74:75], v[72:73], v[64:65] op_sel:[0,0] op_sel_hi:[0,1]
  v_pk_fma_f32 v[82:83], v[70:71], v[56:57], v[82:83] op_sel:[1,1,0] op_sel_hi:[1,0,1] neg_lo:[0,1,0]
  v_pk_fma_f32 v[74:75], v[72:73], v[64:65], v[74:75] op_sel:[1,1,0] op_sel_hi:[1,0,1] neg_lo:[0,1,0]
  v_cvt_pk_bf16_f32 v87, v82, v83
  v_cvt_pk_bf16_f32 v89, v74, v75
  ds_write_b32 v6, v87 offset:4544
  ds_write_b32 v6, v89 offset:176
  v_pk_mul_f32 v[76:77], v[70:71], v[58:59] op_sel:[0,0] op_sel_hi:[0,1]
  v_pk_mul_f32 v[72:73], v[74:75], v[64:65] op_sel:[0,0] op_sel_hi:[0,1]
  v_pk_fma_f32 v[76:77], v[70:71], v[58:59], v[76:77] op_sel:[1,1,0] op_sel_hi:[1,0,1] neg_lo:[0,1,0]
  v_pk_fma_f32 v[72:73], v[74:75], v[64:65], v[72:73] op_sel:[1,1,0] op_sel_hi:[1,0,1] neg_lo:[0,1,0]
  v_cvt_pk_bf16_f32 v84, v76, v77
  v_cvt_pk_bf16_f32 v88, v72, v73
  ds_write_b32 v6, v84 offset:4560
  ds_write_b32 v6, v88 offset:192
  v_pk_mul_f32 v[78:79], v[70:71], v[60:61] op_sel:[0,0] op_sel_hi:[0,1]
  v_pk_mul_f32 v[74:75], v[72:73], v[64:65] op_sel:[0,0] op_sel_hi:[0,1]
  v_pk_fma_f32 v[78:79], v[70:71], v[60:61], v[78:79] op_sel:[1,1,0] op_sel_hi:[1,0,1] neg_lo:[0,1,0]
  v_pk_fma_f32 v[74:75], v[72:73], v[64:65], v[74:75] op_sel:[1,1,0] op_sel_hi:[1,0,1] neg_lo:[0,1,0]
  v_cvt_pk_bf16_f32 v85, v78, v79
  v_cvt_pk_bf16_f32 v89, v74, v75
  ds_write_b32 v6, v85 offset:4576
  ds_write_b32 v6, v89 offset:208
  v_pk_mul_f32 v[80:81], v[70:71], v[62:63] op_sel:[0,0] op_sel_hi:[0,1]
  v_pk_mul_f32 v[72:73], v[74:75], v[64:65] op_sel:[0,0] op_sel_hi:[0,1]
  v_pk_fma_f32 v[80:81], v[70:71], v[62:63], v[80:81] op_sel:[1,1,0] op_sel_hi:[1,0,1] neg_lo:[0,1,0]
  v_pk_fma_f32 v[72:73], v[74:75], v[64:65], v[72:73] op_sel:[1,1,0] op_sel_hi:[1,0,1] neg_lo:[0,1,0]
  v_cvt_pk_bf16_f32 v86, v80, v81
  v_cvt_pk_bf16_f32 v88, v72, v73
  ds_write_b32 v6, v86 offset:4592
  ds_write_b32 v6, v88 offset:224
  v_pk_mul_f32 v[74:75], v[72:73], v[64:65] op_sel:[0,0] op_sel_hi:[0,1]
  v_pk_fma_f32 v[74:75], v[72:73], v[64:65], v[74:75] op_sel:[1,1,0] op_sel_hi:[1,0,1] neg_lo:[0,1,0]
  v_cvt_pk_bf16_f32 v89, v74, v75
  ds_write_b32 v6, v89 offset:240
  ds_read_b128 v[96:99], v46 offset:0
  ds_read_b128 v[100:103], v46 offset:1056
  ds_read_b128 v[104:107], v46 offset:2112
  ds_read_b128 v[108:111], v46 offset:3168
  ds_read_b128 v[112:115], v46 offset:4352
  ds_read_b128 v[116:119], v46 offset:5408
  ds_read_b128 v[120:123], v46 offset:6464
  ds_read_b128 v[124:127], v46 offset:7520
  v_pk_mul_f32 v[66:67], v[70:71], v[70:71] op_sel:[0,0] op_sel_hi:[0,1]
  v_pk_fma_f32 v[66:67], v[70:71], v[70:71], v[66:67] op_sel:[1,1,0] op_sel_hi:[1,0,1] neg_lo:[0,1,0]
  v_pk_mul_f32 v[68:69], v[66:67], v[70:71] op_sel:[0,0] op_sel_hi:[0,1]
  v_pk_fma_f32 v[68:69], v[66:67], v[70:71], v[68:69] op_sel:[1,1,0] op_sel_hi:[1,0,1] neg_lo:[0,1,0]
  v_pk_mul_f32 v[64:65], v[66:67], v[66:67] op_sel:[0,0] op_sel_hi:[0,1]
  v_pk_fma_f32 v[64:65], v[66:67], v[66:67], v[64:65] op_sel:[1,1,0] op_sel_hi:[1,0,1] neg_lo:[0,1,0]
  v_cvt_pk_bf16_f32 v87, v66, v67
  ds_write_b32 v6, v87 offset:0
  v_pk_mul_f32 v[82:83], v[66:67], v[52:53] op_sel:[0,0] op_sel_hi:[0,1]
  v_pk_fma_f32 v[82:83], v[66:67], v[52:53], v[82:83] op_sel:[1,1,0] op_sel_hi:[1,0,1] neg_lo:[0,1,0]
  v_cvt_pk_bf16_f32 v84, v82, v83
  ds_write_b32 v6, v84 offset:16
  s_waitcnt lgkmcnt(2)
  v_mfma_f32_16x16x32_bf16 v[128:131], v[112:115], v[96:99], 0
  v_mfma_f32_16x16x32_bf16 v[128:131], v[116:119], v[100:103], v[128:131]
  v_mfma_f32_16x16x32_bf16 v[128:131], v[120:123], v[104:107], v[128:131]
  v_mfma_f32_16x16x32_bf16 v[128:131], v[124:127], v[108:111], v[128:131]
  v_pk_mul_f32 v[76:77], v[66:67], v[56:57] op_sel:[0,0] op_sel_hi:[0,1]
  v_pk_fma_f32 v[76:77], v[66:67], v[56:57], v[76:77] op_sel:[1,1,0] op_sel_hi:[1,0,1] neg_lo:[0,1,0]
  v_cvt_pk_bf16_f32 v85, v76, v77
  ds_write_b32 v6, v85 offset:32
  v_pk_mul_f32 v[78:79], v[66:67], v[60:61] op_sel:[0,0] op_sel_hi:[0,1]
  v_pk_fma_f32 v[78:79], v[66:67], v[60:61], v[78:79] op_sel:[1,1,0] op_sel_hi:[1,0,1] neg_lo:[0,1,0]
  v_cvt_pk_bf16_f32 v86, v78, v79
  ds_write_b32 v6, v86 offset:48
  v_cvt_pk_bf16_f32 v87, v68, v69
  ds_write_b32 v6, v87 offset:64
  v_pk_mul_f32 v[80:81], v[68:69], v[52:53] op_sel:[0,0] op_sel_hi:[0,1]
  v_pk_fma_f32 v[80:81], v[68:69], v[52:53], v[80:81] op_sel:[1,1,0] op_sel_hi:[1,0,1] neg_lo:[0,1,0]
  v_cvt_pk_bf16_f32 v84, v80, v81
  ds_write_b32 v6, v84 offset:80
  v_pk_mul_f32 v[82:83], v[68:69], v[56:57] op_sel:[0,0] op_sel_hi:[0,1]
  v_pk_fma_f32 v[82:83], v[68:69], v[56:57], v[82:83] op_sel:[1,1,0] op_sel_hi:[1,0,1] neg_lo:[0,1,0]
  v_cvt_pk_bf16_f32 v85, v82, v83
  ds_write_b32 v6, v85 offset:96
  v_pk_mul_f32 v[76:77], v[68:69], v[60:61] op_sel:[0,0] op_sel_hi:[0,1]
  s_cmp_lg_u32 s87, 0
  s_cbranch_scc1 C_xs0
  buffer_load_dwordx2 v[12:13], v36, s[4:7], 0 offen
  s_mov_b64 exec, 7
  buffer_load_dwordx2 v[14:15], v37, s[4:7], 0 offen
  s_mov_b64 exec, -1
C_xs0:
  v_pk_fma_f32 v[76:77], v[68:69], v[60:61], v[76:77] op_sel:[1,1,0] op_sel_hi:[1,0,1] neg_lo:[0,1,0]
  v_cvt_pk_bf16_f32 v86, v76, v77
  ds_write_b32 v6, v86 offset:112
  v_pk_mul_f32 v[50:51], v[64:65], v[70:71] op_sel:[0,0] op_sel_hi:[0,1]
  v_pk_fma_f32 v[50:51], v[64:65], v[70:71], v[50:51] op_sel:[1,1,0] op_sel_hi:[1,0,1] neg_lo:[0,1,0]
  v_pk_mul_f32 v[54:55], v[64:65], v[66:67] op_sel:[0,0] op_sel_hi:[0,1]
  v_pk_fma_f32 v[54:55], v[64:65], v[66:67], v[54:55] op_sel:[1,1,0] op_sel_hi:[1,0,1] neg_lo:[0,1,0]
  v_pk_mul_f32 v[58:59], v[64:65], v[68:69] op_sel:[0,0] op_sel_hi:[0,1]
  v_pk_fma_f32 v[58:59], v[64:65], v[68:69], v[58:59] op_sel:[1,1,0] op_sel_hi:[1,0,1] neg_lo:[0,1,0]
  v_cvt_pk_bf16_f32 v87, v64, v65
  ds_write_b32 v6, v87 offset:128
  v_pk_mul_f32 v[78:79], v[64:65], v[56:57] op_sel:[0,0] op_sel_hi:[0,1]
  s_cmp_lg_u32 s87, 1
  s_cbranch_scc1 C_xs1
  buffer_load_dwordx2 v[12:13], v36, s[4:7], 0 offen
  s_mov_b64 exec, 7
  buffer_load_dwordx2 v[14:15], v37, s[4:7], 0 offen
  s_mov_b64 exec, -1
C_xs1:
  v_pk_fma_f32 v[78:79], v[64:65], v[56:57], v[78:79] op_sel:[1,1,0] op_sel_hi:[1,0,1] neg_lo:[0,1,0]
  v_cvt_pk_bf16_f32 v84, v78, v79
  ds_write_b32 v6, v84 offset:144
  v_cvt_pk_bf16_f32 v85, v50, v51
  ds_write_b32 v6, v85 offset:160
  v_pk_mul_f32 v[80:81], v[50:51], v[56:57] op_sel:[0,0] op_sel_hi:[0,1]
  v_pk_fma_f32 v[80:81], v[50:51], v[56:57], v[80:81] op_sel:[1,1,0] op_sel_hi:[1,0,1] neg_lo:[0,1,0]
  v_cvt_pk_bf16_f32 v86, v80, v81
  ds_write_b32 v6, v86 offset:176
  v_cvt_pk_bf16_f32 v87, v54, v55
  ds_write_b32 v6, v87 offset:192
  v_pk_mul_f32 v[82:83], v[54:55], v[56:57] op_sel:[0,0] op_sel_hi:[0,1]
  s_cmp_lg_u32 s87, 2
  s_cbranch_scc1 C_xs2
  buffer_load_dwordx2 v[12:13], v36, s[4:7], 0 offen
  s_mov_b64 exec, 7
  buffer_load_dwordx2 v[14:15], v37, s[4:7], 0 offen
  s_mov_b64 exec, -1
C_xs2:
  v_pk_fma_f32 v[82:83], v[54:55], v[56:57], v[82:83] op_sel:[1,1,0] op_sel_hi:[1,0,1] neg_lo:[0,1,0]
  v_cvt_pk_bf16_f32 v84, v82, v83
  ds_write_b32 v6, v84 offset:208
  v_cvt_pk_bf16_f32 v85, v58, v59
  ds_write_b32 v6, v85 offset:224
  v_pk_mul_f32 v[76:77], v[58:59], v[56:57] op_sel:[0,0] op_sel_hi:[0,1]
  v_pk_fma_f32 v[76:77], v[58:59], v[56:57], v[76:77] op_sel:[1,1,0] op_sel_hi:[1,0,1] neg_lo:[0,1,0]
  v_cvt_pk_bf16_f32 v86, v76, v77
  ds_write_b32 v6, v86 offset:240
  ds_read_b128 v[112:115], v46 offset:0
  ds_read_b128 v[116:119], v46 offset:1056
  ds_read_b128 v[120:123], v46 offset:2112
  s_cmp_lg_u32 s87, 3
  s_cbranch_scc1 C_xs3
  buffer_load_dwordx2 v[12:13], v36, s[4:7], 0 offen
  s_mov_b64 exec, 7
  buffer_load_dwordx2 v[14:15], v37, s[4:7], 0 offen
  s_mov_b64 exec, -1
C_xs3:
  ds_read_b128 v[124:127], v46 offset:3168
  v_pk_mul_f32 v[72:73], v[64:65], v[64:65] op_sel:[0,0] op_sel_hi:[0,1]
  v_pk_fma_f32 v[72:73], v[64:65], v[64:65], v[72:73] op_sel:[1,1,0] op_sel_hi:[1,0,1] neg_lo:[0,1,0]
  v_cvt_pk_bf16_f32 v87, v72, v73
  ds_write_b32 v6, v87 offset:4352
  v_pk_mul_f32 v[78:79], v[64:65], v[50:51] op_sel:[0,0] op_sel_hi:[0,1]
  v_pk_fma_f32 v[78:79], v[64:65], v[50:51], v[78:79] op_sel:[1,1,0] op_sel_hi:[1,0,1] neg_lo:[0,1,0]
  v_cvt_pk_bf16_f32 v84, v78, v79
  ds_write_b32 v6, v84 offset:4368
  v_pk_mul_f32 v[80:81], v[64:65], v[54:55] op_sel:[0,0] op_sel_hi:[0,1]
  v_pk_fma_f32 v[80:81], v[64:65], v[54:55], v[80:81] op_sel:[1,1,0] op_sel_hi:[1,0,1] neg_lo:[0,1,0]
  v_cvt_pk_bf16_f32 v85, v80, v81
  s_cmp_lg_u32 s87, 0
  s_cbranch_scc1 C_xs4
  v_add_u32 v36, 524288, v36
  v_add_u32 v37, 524288, v37
  buffer_load_dwordx2 v[16:17], v36, s[4:7], 0 offen
  s_mov_b64 exec, 7
  buffer_load_dwordx2 v[18:19], v37, s[4:7], 0 offen
  s_mov_b64 exec, -1
C_xs4:
  ds_write_b32 v6, v85 offset:4384
  s_waitcnt lgkmcnt(3)
  v_mfma_f32_16x16x32_bf16 v[132:135], v[112:115], v[96:99], 0
  v_mfma_f32_16x16x32_bf16 v[132:135], v[116:119], v[100:103], v[132:135]
  v_mfma_f32_16x16x32_bf16 v[132:135], v[120:123], v[104:107], v[132:135]
  v_mfma_f32_16x16x32_bf16 v[132:135], v[124:127], v[108:111], v[132:135]
  v_pk_mul_f32 v[82:83], v[64:65], v[58:59] op_sel:[0,0] op_sel_hi:[0,1]
  v_pk_fma_f32 v[82:83], v[64:65], v[58:59], v[82:83] op_sel:[1,1,0] op_sel_hi:[1,0,1] neg_lo:[0,1,0]
  v_cvt_pk_bf16_f32 v86, v82, v83
  ds_write_b32 v6, v86 offset:4400
  v_pk_mul_f32 v[76:77], v[72:73], v[64:65] op_sel:[0,0] op_sel_hi:[0,1]
  v_pk_fma_f32 v[76:77], v[72:73], v[64:65], v[76:77] op_sel:[1,1,0] op_sel_hi:[1,0,1] neg_lo:[0,1,0]
  s_cmp_lg_u32 s87, 1
  s_cbranch_scc1 C_xs5
  v_add_u32 v36, 524288, v36
  v_add_u32 v37, 524288, v37
  buffer_load_dwordx2 v[16:17], v36, s[4:7], 0 offen
  s_mov_b64 exec, 7
  buffer_load_dwordx2 v[18:19], v37, s[4:7], 0 offen
  s_mov_b64 exec, -1
C_xs5:
  v_cvt_pk_bf16_f32 v87, v76, v77
  ds_write_b32 v6, v87 offset:4416
  v_pk_mul_f32 v[78:79], v[72:73], v[50:51] op_sel:[0,0] op_sel_hi:[0,1]
  v_pk_fma_f32 v[78:79], v[72:73], v[50:51], v[78:79] op_sel:[1,1,0] op_sel_hi:[1,0,1] neg_lo:[0,1,0]
  v_cvt_pk_bf16_f32 v84, v78, v79
  ds_write_b32 v6, v84 offset:4432
  v_pk_mul_f32 v[80:81], v[72:73], v[54:55] op_sel:[0,0] op_sel_hi:[0,1]
  v_pk_fma_f32 v[80:81], v[72:73], v[54:55], v[80:81] op_sel:[1,1,0] op_sel_hi:[1,0,1] neg_lo:[0,1,0]
  v_cvt_pk_bf16_f32 v85, v80, v81
  ds_write_b32 v6, v85 offset:4448
  v_pk_mul_f32 v[82:83], v[72:73], v[58:59] op_sel:[0,0] op_sel_hi:[0,1]
  v_pk_fma_f32 v[82:83], v[72:73], v[58:59], v[82:83] op_sel:[1,1,0] op_sel_hi:[1,0,1] neg_lo:[0,1,0]
  s_cmp_lg_u32 s87, 2
  s_cbranch_scc1 C_xs6
  v_add_u32 v36, 524288, v36
  v_add_u32 v37, 524288, v37
  buffer_load_dwordx2 v[16:17], v36, s[4:7], 0 offen
  s_mov_b64 exec, 7
  buffer_load_dwordx2 v[18:19], v37, s[4:7], 0 offen
  s_mov_b64 exec, -1
C_xs6:
  v_cvt_pk_bf16_f32 v86, v82, v83
  ds_write_b32 v6, v86 offset:4464
  v_pk_mul_f32 v[76:77], v[72:73], v[72:73] op_sel:[0,0] op_sel_hi:[0,1]
  v_pk_fma_f32 v[76:77], v[72:73], v[72:73], v[76:77] op_sel:[1,1,0] op_sel_hi:[1,0,1] neg_lo:[0,1,0]
  v_cvt_pk_bf16_f32 v87, v76, v77
  ds_write_b32 v6, v87 offset:4480
  ds_read_b128 v[112:115], v46 offset:4352
  ds_read_b128 v[116:119], v46 offset:5408
  ds_read_b128 v[120:123], v46 offset:6464
  ds_read_b128 v[124:127], v46 offset:7520
  v_lshrrev_b32 v5, 1, v3
  v_lshlrev_b32 v84, 9, v5
  s_cmp_lg_u32 s87, 3
  s_cbranch_scc1 C_xs7
  v_add_u32 v36, 524288, v36
  v_add_u32 v37, 524288, v37
  buffer_load_dwordx2 v[16:17], v36, s[4:7], 0 offen
  s_mov_b64 exec, 7
  buffer_load_dwordx2 v[18:19], v37, s[4:7], 0 offen
  s_mov_b64 exec, -1
C_xs7:
  v_lshl_add_u32 v84, v2, 5, v84
  v_and_b32 v4, 1, v3
  v_lshl_add_u32 v84, v4, 4, v84
  v_add_u32 v84, s84, v84
  v_sub_u32 v4, 4, v5
  v_lshlrev_b32 v85, v4, v2
  v_lshl_add_u32 v85, v3, 8, v85
  v_add_u32 v85, s84, v85
  v_mul_u32_u24 v86, 120, v5
  v_add_u32 v86, v86, v85
  v_lshlrev_b32 v87, 8, v3
  v_lshl_add_u32 v87, v2, 2, v87
  v_add_u32 v87, s84, v87
  v_add_f32 v128, v128, v45
  ds_write_b128 v84, v[128:131]
  ds_write_b64 v85, v[132:133] offset:1024
  ds_write_b64 v86, v[134:135] offset:1032
  s_waitcnt lgkmcnt(3)
  v_mfma_f32_16x16x32_bf16 v[136:139], v[112:115], v[96:99], 0
  v_mfma_f32_16x16x32_bf16 v[136:139], v[116:119], v[100:103], v[136:139]
  v_mfma_f32_16x16x32_bf16 v[136:139], v[120:123], v[104:107], v[136:139]
  v_mfma_f32_16x16x32_bf16 v[136:139], v[124:127], v[108:111], v[136:139]
  s_waitcnt vmcnt(2)
  ds_write_b64 v7, v[12:13] offset:24
  s_mov_b64 exec, 7
  ds_write_b64 v7, v[14:15] offset:0
  s_mov_b64 exec, -1
  ds_read_b64_tr_b16 v[28:29], v8 offset:24
  ds_read_b64_tr_b16 v[30:31], v8 offset:0
  ds_read_b64_tr_b16 v[32:33], v8 offset:8
  ds_read_b64_tr_b16 v[34:35], v8 offset:16
  ds_write_b32 v87, v136 offset:2048
  ds_write_b32 v87, v137 offset:2112
  ds_write_b32 v87, v138 offset:2176
  ds_write_b32 v87, v139 offset:2240
  s_waitcnt lgkmcnt(4)
  ds_write_b64 v9, v[28:29] offset:8
  ds_write_b64 v9, v[30:31] offset:4272
  ds_write_b64 v9, v[32:33] offset:8544
  ds_write_b64 v9, v[34:35] offset:12816
  s_waitcnt lgkmcnt(0)
  s_barrier
  s_mul_i32 s77, s74, 17408
  s_add_u32 s77, s77, 90112
  v_lshl_add_u32 v4, v2, 2, v3
  s_lshl_b32 s76, s75, 8
  s_add_u32 s76, s76, s77
  v_lshl_add_u32 v5, v4, 2, s76
  ds_read_b32 v58, v5 offset:2048
  ds_read_b32 v59, v5 offset:2052
  ds_read_b32 v60, v5 offset:10752
  ds_read_b32 v61, v5 offset:10756
  s_movk_i32 s78, 1280
  v_mul_u32_u24 v62, s78, v3
  v_lshl_add_u32 v62, v2, 4, v62
  v_add_u32 v62, s77, v62
  s_cmp_eq_u32 s75, 1
  s_cbranch_scc1 C_exp1
  v_lshrrev_b32 v63, 3, v2
  v_sub_u32 v5, 5, v63
  v_lshlrev_b32 v5, v5, v4
  v_lshl_add_u32 v5, v63, 9, v5
  v_add_u32 v5, s77, v5
  ds_read_b128 v[38:41], v5
  ds_read_b128 v[42:45], v5 offset:16
  ds_read_b128 v[46:49], v5 offset:8704
  ds_read_b128 v[50:53], v5 offset:8720
  v_sub_u32 v63, 0, v63
  v_mov_b32 v54, 0
  v_mov_b32 v55, 0
  v_mov_b32 v56, 0
  v_mov_b32 v57, 0
  ds_write_b128 v62, v[54:57] offset:3072
  s_waitcnt lgkmcnt(0)
  v_pk_add_f32 v[38:39], v[38:39], v[46:47]
  v_pk_add_f32 v[40:41], v[40:41], v[48:49]
  v_pk_add_f32 v[42:43], v[42:43], v[50:51]
  v_pk_add_f32 v[44:45], v[44:45], v[52:53]
  v_cvt_pk_bf16_f32 v64, v42, v41
  v_cvt_pk_bf16_f32 v65, v40, v40
  v_cvt_pk_bf16_f32 v66, v40, v39
  v_cvt_pk_bf16_f32 v67, v38, v38
  v_cvt_pk_bf16_f32 v54, v45, v44
  v_cvt_pk_bf16_f32 v55, v43, v42
  v_cvt_pk_bf16_f32 v56, v41, v40
  v_cvt_pk_bf16_f32 v57, v39, v38
  v_bfi_b32 v54, v63, v64, v54
  v_bfi_b32 v55, v63, v65, v55
  v_bfi_b32 v56, v63, v66, v56
  v_bfi_b32 v57, v63, v67, v57
  ds_write_b128 v62, v[54:57] offset:3328
  s_branch C_exp2
C_exp1:
  v_lshl_add_u32 v5, v4, 3, s77
  ds_read_b64 v[38:39], v5 offset:1536
  ds_read_b32 v40, v5 offset:1544
  ds_read_b64 v[46:47], v5 offset:10240
  ds_read_b32 v48, v5 offset:10248
  s_waitcnt lgkmcnt(0)
  v_pk_add_f32 v[38:39], v[38:39], v[46:47]
  v_add_f32 v40, v40, v48
  v_cvt_pk_bf16_f32 v54, v40, v40
  v_cvt_pk_bf16_f32 v55, v39, v39
  v_cvt_pk_bf16_f32 v56, v39, v38
  v_cvt_pk_bf16_f32 v57, v38, v38
  ds_write_b128 v62, v[54:57] offset:3584
C_exp2:
  v_pk_add_f32 v[58:59], v[58:59], v[60:61]
  v_and_b32 v63, 1, v3
  v_sub_u32 v63, 0, v63
  v_bfi_b32 v38, v63, v59, v58
  v_cvt_pk_bf16_f32 v42, v59, v59
  v_cvt_pk_bf16_f32 v43, v59, v38
  v_cvt_pk_bf16_f32 v44, v58, v58
  v_mov_b32 v45, v44
  s_lshl_b32 s76, s75, 8
  v_add_u32 v5, s76, v62
  ds_write_b128 v5, v[42:45] offset:3840
  s_lshl_b32 s76, s75, 7
  v_subrev_u32 v6, s76, v62
  v_and_b32 v4, 3, v1
  v_add_u32 v4, 1, v4
  v_and_b32 v5, 3, v4
  s_movk_i32 s76, 4272
  v_mul_u32_u24 v234, s76, v5
  v_lshrrev_b32 v4, 2, v4
  v_lshl_add_u32 v234, v4, 3, v234
  v_bfe_u32 v4, v1, 2, 2
  v_sub_u32 v4, v4, v3
  v_lshlrev_b32 v4, 4, v4
  v_add_u32 v234, v234, v4
  s_mul_i32 s76, s74, 17120
  s_lshl_b32 s77, s75, 9
  s_add_u32 s76, s76, s77
  s_add_u32 s76, s76, 48
  v_add_u32 v234, s76, v234
  ds_read_b64 v[198:199], v234 offset:0
  ds_read_b64 v[200:201], v234 offset:8
  ds_read_b64 v[202:203], v234 offset:16
  ds_read_b64 v[204:205], v234 offset:64
  ds_read_b64 v[206:207], v234 offset:72
  ds_read_b64 v[208:209], v234 offset:80
  s_add_u32 s16, s68, 0x600000
  s_addc_u32 s17, s69, 0
  s_mov_b32 s18, 0x1b000
  s_mov_b32 s19, 0x20000
  s_mov_b32 s20, s42
  s_mov_b32 s21, s43
  s_mov_b32 s22, 0x80000
  s_mov_b32 s23, 0x20000
  s_mov_b32 s24, s62
  s_mov_b32 s25, s63
  s_mov_b32 s26, 0x400
  s_mov_b32 s27, 0x20000
  v_lshrrev_b32 v4, 4, v1
  v_lshlrev_b32 v11, 2, v4
  v_xor_b32 v11, v11, v1
  v_and_b32 v11, 15, v11
  v_lshlrev_b32 v11, 4, v11
  v_lshl_add_u32 v11, v4, 10, v11
  v_lshlrev_b32 v235, 4, v1
  s_waitcnt lgkmcnt(0)
  s_barrier
  ds_read_b128 v[38:41], v6 offset:3328
  ds_read_b128 v[42:45], v6 offset:3584
  ds_read_b128 v[46:49], v6 offset:3840
  ds_read_b128 v[50:53], v6 offset:4096
  ds_read_b128 v[54:57], v6 offset:3312
  ds_read_b128 v[58:61], v6 offset:3568
  ds_read_b128 v[62:65], v6 offset:3824
  ds_read_b128 v[66:69], v6 offset:4080
  s_waitcnt lgkmcnt(4)
  v_mfma_f32_16x16x32_bf16 v[166:169], v[198:201], v[38:41], 0
  ds_read_b64 v[210:211], v234 offset:128
  v_mfma_f32_16x16x32_bf16 v[170:173], v[200:203], v[38:41], 0
  ds_read_b64 v[212:213], v234 offset:136
  v_mfma_f32_16x16x32_bf16 v[174:177], v[198:201], v[42:45], 0
  ds_read_b64 v[214:215], v234 offset:144
  v_mfma_f32_16x16x32_bf16 v[178:181], v[200:203], v[42:45], 0
  ds_read_b128 v[70:73], v6 offset:3296
  v_mfma_f32_16x16x32_bf16 v[182:185], v[198:201], v[46:49], 0
  ds_read_b128 v[74:77], v6 offset:3552
  v_mfma_f32_16x16x32_bf16 v[186:189], v[200:203], v[46:49], 0
  ds_read_b128 v[78:81], v6 offset:3808
  v_mfma_f32_16x16x32_bf16 v[190:193], v[198:201], v[50:53], 0
  ds_read_b128 v[82:85], v6 offset:4064
  v_mfma_f32_16x16x32_bf16 v[194:197], v[200:203], v[50:53], 0
  s_cmp_lg_u32 s87, 0
  s_cbranch_scc1 C_xs8
  v_add_u32 v36, 524288, v36
  v_add_u32 v37, 524288, v37
  buffer_load_dwordx2 v[20:21], v36, s[4:7], 0 offen
  s_mov_b64 exec, 7
  buffer_load_dwordx2 v[22:23], v37, s[4:7], 0 offen
  s_mov_b64 exec, -1
C_xs8:
  s_waitcnt lgkmcnt(7)
  v_mfma_f32_16x16x32_bf16 v[166:169], v[204:207], v[54:57], v[166:169]
  ds_read_b64 v[216:217], v234 offset:192
  v_mfma_f32_16x16x32_bf16 v[170:173], v[206:209], v[54:57], v[170:173]
  ds_read_b64 v[218:219], v234 offset:200
  v_mfma_f32_16x16x32_bf16 v[174:177], v[204:207], v[58:61], v[174:177]
  ds_read_b64 v[220:221], v234 offset:208
  v_mfma_f32_16x16x32_bf16 v[178:181], v[206:209], v[58:61], v[178:181]
  ds_read_b128 v[86:89], v6 offset:3280
  v_mfma_f32_16x16x32_bf16 v[182:185], v[204:207], v[62:65], v[182:185]
  ds_read_b128 v[90:93], v6 offset:3536
  v_mfma_f32_16x16x32_bf16 v[186:189], v[206:209], v[62:65], v[186:189]
  ds_read_b128 v[94:97], v6 offset:3792
  v_mfma_f32_16x16x32_bf16 v[190:193], v[204:207], v[66:69], v[190:193]
  ds_read_b128 v[98:101], v6 offset:4048
  v_mfma_f32_16x16x32_bf16 v[194:197], v[206:209], v[66:69], v[194:197]
  s_cmp_lg_u32 s87, 1
  s_cbranch_scc1 C_xs9
  v_add_u32 v36, 524288, v36
  v_add_u32 v37, 524288, v37
  buffer_load_dwordx2 v[20:21], v36, s[4:7], 0 offen
  s_mov_b64 exec, 7
  buffer_load_dwordx2 v[22:23], v37, s[4:7], 0 offen
  s_mov_b64 exec, -1
C_xs9:
  s_waitcnt lgkmcnt(7)
  v_mfma_f32_16x16x32_bf16 v[166:169], v[210:213], v[70:73], v[166:169]
  ds_read_b64 v[222:223], v234 offset:256
  v_mfma_f32_16x16x32_bf16 v[170:173], v[212:215], v[70:73], v[170:173]
  ds_read_b64 v[224:225], v234 offset:264
  v_mfma_f32_16x16x32_bf16 v[174:177], v[210:213], v[74:77], v[174:177]
  ds_read_b64 v[226:227], v234 offset:272
  v_mfma_f32_16x16x32_bf16 v[178:181], v[212:215], v[74:77], v[178:181]
  ds_read_b128 v[102:105], v6 offset:3264
  v_mfma_f32_16x16x32_bf16 v[182:185], v[210:213], v[78:81], v[182:185]
  ds_read_b128 v[106:109], v6 offset:3520
  v_mfma_f32_16x16x32_bf16 v[186:189], v[212:215], v[78:81], v[186:189]
  ds_read_b128 v[110:113], v6 offset:3776
  v_mfma_f32_16x16x32_bf16 v[190:193], v[210:213], v[82:85], v[190:193]
  ds_read_b128 v[114:117], v6 offset:4032
  v_mfma_f32_16x16x32_bf16 v[194:197], v[212:215], v[82:85], v[194:197]
  s_cmp_lg_u32 s87, 2
  s_cbranch_scc1 C_xs10
  v_add_u32 v36, 524288, v36
  v_add_u32 v37, 524288, v37
  buffer_load_dwordx2 v[20:21], v36, s[4:7], 0 offen
  s_mov_b64 exec, 7
  buffer_load_dwordx2 v[22:23], v37, s[4:7], 0 offen
  s_mov_b64 exec, -1
C_xs10:
  s_waitcnt lgkmcnt(7)
  v_mfma_f32_16x16x32_bf16 v[166:169], v[216:219], v[86:89], v[166:169]
  ds_read_b64 v[228:229], v234 offset:320
  ds_read_b64 v[230:231], v234 offset:328
  v_mfma_f32_16x16x32_bf16 v[170:173], v[218:221], v[86:89], v[170:173]
  ds_read_b64 v[232:233], v234 offset:336
  ds_read_b128 v[118:121], v6 offset:3248
  v_mfma_f32_16x16x32_bf16 v[174:177], v[216:219], v[90:93], v[174:177]
  ds_read_b128 v[122:125], v6 offset:3504
  ds_read_b128 v[126:129], v6 offset:3760
  v_mfma_f32_16x16x32_bf16 v[178:181], v[218:221], v[90:93], v[178:181]
  ds_read_b128 v[130:133], v6 offset:4016
  v_mfma_f32_16x16x32_bf16 v[182:185], v[216:219], v[94:97], v[182:185]
  s_cmp_lg_u32 s87, 3
  s_cbranch_scc1 C_xs11
  v_add_u32 v36, 524288, v36
  v_add_u32 v37, 524288, v37
  buffer_load_dwordx2 v[20:21], v36, s[4:7], 0 offen
  s_mov_b64 exec, 7
  buffer_load_dwordx2 v[22:23], v37, s[4:7], 0 offen
  s_mov_b64 exec, -1
C_xs11:
  s_waitcnt vmcnt(2)
  ds_write_b64 v7, v[16:17] offset:568
  v_mfma_f32_16x16x32_bf16 v[186:189], v[218:221], v[94:97], v[186:189]
  s_mov_b64 exec, 7
  ds_write_b64 v7, v[18:19] offset:544
  s_mov_b64 exec, -1
  ds_read_b64_tr_b16 v[28:29], v8 offset:568
  v_mfma_f32_16x16x32_bf16 v[190:193], v[216:219], v[98:101], v[190:193]
  ds_read_b64_tr_b16 v[30:31], v8 offset:544
  ds_read_b64_tr_b16 v[32:33], v8 offset:552
  v_mfma_f32_16x16x32_bf16 v[194:197], v[218:221], v[98:101], v[194:197]
  ds_read_b64_tr_b16 v[34:35], v8 offset:560
  s_waitcnt lgkmcnt(13)
  v_mfma_f32_16x16x32_bf16 v[166:169], v[222:225], v[102:105], v[166:169]
  ds_read_b64 v[198:199], v234 offset:384
  ds_read_b64 v[200:201], v234 offset:392
  v_mfma_f32_16x16x32_bf16 v[170:173], v[224:227], v[102:105], v[170:173]
  ds_read_b64 v[202:203], v234 offset:400
  v_mfma_f32_16x16x32_bf16 v[174:177], v[222:225], v[106:109], v[174:177]
  ds_read_b128 v[134:137], v6 offset:3232
  ds_read_b128 v[138:141], v6 offset:3488
  v_mfma_f32_16x16x32_bf16 v[178:181], v[224:227], v[106:109], v[178:181]
  ds_read_b128 v[142:145], v6 offset:3744
  v_mfma_f32_16x16x32_bf16 v[182:185], v[222:225], v[110:113], v[182:185]
  ds_read_b128 v[146:149], v6 offset:4000
  s_cmp_lg_u32 s87, 0
  s_cbranch_scc1 C_xs12
  v_add_u32 v36, 524288, v36
  v_add_u32 v37, 524288, v37
  buffer_load_dwordx2 v[24:25], v36, s[4:7], 0 offen
  s_mov_b64 exec, 7
  buffer_load_dwordx2 v[26:27], v37, s[4:7], 0 offen
  s_mov_b64 exec, -1
C_xs12:
  v_mfma_f32_16x16x32_bf16 v[186:189], v[224:227], v[110:113], v[186:189]
  s_waitcnt lgkmcnt(7)
  ds_write_b64 v9, v[28:29] offset:1032
  v_mfma_f32_16x16x32_bf16 v[190:193], v[222:225], v[114:117], v[190:193]
  ds_write_b64 v9, v[30:31] offset:5296
  ds_write_b64 v9, v[32:33] offset:9568
  v_mfma_f32_16x16x32_bf16 v[194:197], v[224:227], v[114:117], v[194:197]
  ds_write_b64 v9, v[34:35] offset:13840
  v_mfma_f32_16x16x32_bf16 v[166:169], v[228:231], v[118:121], v[166:169]
  ds_read_b64 v[204:205], v234 offset:448
  v_mfma_f32_16x16x32_bf16 v[170:173], v[230:233], v[118:121], v[170:173]
  ds_read_b64 v[206:207], v234 offset:456
  v_mfma_f32_16x16x32_bf16 v[174:177], v[228:231], v[122:125], v[174:177]
  ds_read_b64 v[208:209], v234 offset:464
  v_mfma_f32_16x16x32_bf16 v[178:181], v[230:233], v[122:125], v[178:181]
  ds_read_b128 v[150:153], v6 offset:3216
  v_mfma_f32_16x16x32_bf16 v[182:185], v[228:231], v[126:129], v[182:185]
  ds_read_b128 v[154:157], v6 offset:3472
  v_mfma_f32_16x16x32_bf16 v[186:189], v[230:233], v[126:129], v[186:189]
  ds_read_b128 v[158:161], v6 offset:3728
  v_mfma_f32_16x16x32_bf16 v[190:193], v[228:231], v[130:133], v[190:193]
  ds_read_b128 v[162:165], v6 offset:3984
  v_mfma_f32_16x16x32_bf16 v[194:197], v[230:233], v[130:133], v[194:197]
  s_cmp_lg_u32 s87, 1
  s_cbranch_scc1 C_xs13
  v_add_u32 v36, 524288, v36
  v_add_u32 v37, 524288, v37
  buffer_load_dwordx2 v[24:25], v36, s[4:7], 0 offen
  s_mov_b64 exec, 7
  buffer_load_dwordx2 v[26:27], v37, s[4:7], 0 offen
  s_mov_b64 exec, -1
C_xs13:
  s_waitcnt lgkmcnt(11)
  v_mfma_f32_16x16x32_bf16 v[166:169], v[198:201], v[134:137], v[166:169]
  s_waitcnt lgkmcnt(7)
  s_barrier
  ds_read_b64 v[210:211], v234 offset:1024
  v_mfma_f32_16x16x32_bf16 v[170:173], v[200:203], v[134:137], v[170:173]
  ds_read_b64 v[212:213], v234 offset:1032
  v_mfma_f32_16x16x32_bf16 v[174:177], v[198:201], v[138:141], v[174:177]
  ds_read_b64 v[214:215], v234 offset:1040
  ds_read_b64 v[216:217], v234 offset:1088
  v_mfma_f32_16x16x32_bf16 v[178:181], v[200:203], v[138:141], v[178:181]
  ds_read_b64 v[218:219], v234 offset:1096
  v_mfma_f32_16x16x32_bf16 v[182:185], v[198:201], v[142:145], v[182:185]
  ds_read_b64 v[220:221], v234 offset:1104
  v_mfma_f32_16x16x32_bf16 v[186:189], v[200:203], v[142:145], v[186:189]
  ds_read_b64 v[222:223], v234 offset:1152
  ds_read_b64 v[224:225], v234 offset:1160
  v_mfma_f32_16x16x32_bf16 v[190:193], v[198:201], v[146:149], v[190:193]
  ds_read_b64 v[226:227], v234 offset:1168
  v_mfma_f32_16x16x32_bf16 v[194:197], v[200:203], v[146:149], v[194:197]
  s_cmp_lg_u32 s87, 2
  s_cbranch_scc1 C_xs14
  v_add_u32 v36, 524288, v36
  v_add_u32 v37, 524288, v37
  buffer_load_dwordx2 v[24:25], v36, s[4:7], 0 offen
  s_mov_b64 exec, 7
  buffer_load_dwordx2 v[26:27], v37, s[4:7], 0 offen
  s_mov_b64 exec, -1
C_xs14:
  s_waitcnt lgkmcnt(9)
  v_mfma_f32_16x16x32_bf16 v[166:169], v[204:207], v[150:153], v[166:169]
  ds_read_b64 v[228:229], v234 offset:1216
  v_mfma_f32_16x16x32_bf16 v[170:173], v[206:209], v[150:153], v[170:173]
  v_mfma_f32_16x16x32_bf16 v[174:177], v[204:207], v[154:157], v[174:177]
  ds_read_b64 v[230:231], v234 offset:1224
  v_mfma_f32_16x16x32_bf16 v[178:181], v[206:209], v[154:157], v[178:181]
  v_mfma_f32_16x16x32_bf16 v[182:185], v[204:207], v[158:161], v[182:185]
  ds_read_b64 v[232:233], v234 offset:1232
  v_mfma_f32_16x16x32_bf16 v[186:189], v[206:209], v[158:161], v[186:189]
  v_mfma_f32_16x16x32_bf16 v[190:193], v[204:207], v[162:165], v[190:193]
  s_cmp_lg_u32 s87, 3
  s_cbranch_scc1 C_xs15
  v_add_u32 v36, 524288, v36
  v_add_u32 v37, 524288, v37
  buffer_load_dwordx2 v[24:25], v36, s[4:7], 0 offen
  s_mov_b64 exec, 7
  buffer_load_dwordx2 v[26:27], v37, s[4:7], 0 offen
  s_mov_b64 exec, -1
C_xs15:
  v_mfma_f32_16x16x32_bf16 v[194:197], v[206:209], v[162:165], v[194:197]
  s_waitcnt lgkmcnt(9)
  v_mfma_f32_16x16x32_bf16 v[174:177], v[210:213], v[38:41], v[174:177]
  ds_read_b64 v[198:199], v234 offset:1280
  v_mfma_f32_16x16x32_bf16 v[178:181], v[212:215], v[38:41], v[178:181]
  ds_read_b64 v[200:201], v234 offset:1288
  v_mfma_f32_16x16x32_bf16 v[182:185], v[210:213], v[42:45], v[182:185]
  v_mfma_f32_16x16x32_bf16 v[186:189], v[212:215], v[42:45], v[186:189]
  ds_read_b64 v[202:203], v234 offset:1296
  v_mfma_f32_16x16x32_bf16 v[190:193], v[210:213], v[46:49], v[190:193]
  s_mov_b32 s28, s42
  s_mov_b32 s29, s43
  s_mov_b32 s30, 0x80000
  s_mov_b32 s31, 0x20000
  s_cmp_lt_u32 s72, 4
  s_cbranch_scc1 C_pb3
  s_lshl_b32 s78, s72, 4
  s_add_u32 s78, s78, s89
  s_sub_u32 s78, s78, 64
  s_lshl_b32 s78, s78, 13
  v_lshlrev_b32 v5, 7, v1
  buffer_load_dword v10, v5, s[28:31], s78 offen
C_pb3:
  v_mfma_f32_16x16x32_bf16 v[194:197], v[212:215], v[46:49], v[194:197]
  s_waitcnt lgkmcnt(9)
  v_mfma_f32_16x16x32_bf16 v[174:177], v[216:219], v[54:57], v[174:177]
  ds_read_b64 v[204:205], v234 offset:1344
  ds_read_b64 v[206:207], v234 offset:1352
  v_mfma_f32_16x16x32_bf16 v[178:181], v[218:221], v[54:57], v[178:181]
  ds_read_b64 v[208:209], v234 offset:1360
  v_mfma_f32_16x16x32_bf16 v[182:185], v[216:219], v[58:61], v[182:185]
  s_waitcnt vmcnt(2)
  ds_write_b64 v7, v[20:21] offset:1112
  s_mov_b64 exec, 7
  ds_write_b64 v7, v[22:23] offset:1088
  s_mov_b64 exec, -1
  v_mfma_f32_16x16x32_bf16 v[186:189], v[218:221], v[58:61], v[186:189]
  ds_read_b64_tr_b16 v[28:29], v8 offset:1112
  v_mfma_f32_16x16x32_bf16 v[190:193], v[216:219], v[62:65], v[190:193]
  ds_read_b64_tr_b16 v[30:31], v8 offset:1088
  ds_read_b64_tr_b16 v[32:33], v8 offset:1096
  v_mfma_f32_16x16x32_bf16 v[194:197], v[218:221], v[62:65], v[194:197]
  ds_read_b64_tr_b16 v[34:35], v8 offset:1104
  s_waitcnt lgkmcnt(15)
  v_mfma_f32_16x16x32_bf16 v[174:177], v[222:225], v[70:73], v[174:177]
  ds_read_b64 v[210:211], v234 offset:1408
  ds_read_b64 v[212:213], v234 offset:1416
  v_mfma_f32_16x16x32_bf16 v[178:181], v[224:227], v[70:73], v[178:181]
  ds_read_b64 v[214:215], v234 offset:1424
  v_mfma_f32_16x16x32_bf16 v[182:185], v[222:225], v[74:77], v[182:185]
  s_waitcnt lgkmcnt(3)
  ds_write_b64 v9, v[28:29] offset:2056
  v_mfma_f32_16x16x32_bf16 v[186:189], v[224:227], v[74:77], v[186:189]
  ds_write_b64 v9, v[30:31] offset:6320
  v_mfma_f32_16x16x32_bf16 v[190:193], v[222:225], v[78:81], v[190:193]
  ds_write_b64 v9, v[32:33] offset:10592
  v_mfma_f32_16x16x32_bf16 v[194:197], v[224:227], v[78:81], v[194:197]
  ds_write_b64 v9, v[34:35] offset:14864
  v_mfma_f32_16x16x32_bf16 v[174:177], v[228:231], v[86:89], v[174:177]
  ds_read_b64 v[216:217], v234 offset:1472
  v_mfma_f32_16x16x32_bf16 v[178:181], v[230:233], v[86:89], v[178:181]
  v_mfma_f32_16x16x32_bf16 v[182:185], v[228:231], v[90:93], v[182:185]
  ds_read_b64 v[218:219], v234 offset:1480
  v_mfma_f32_16x16x32_bf16 v[186:189], v[230:233], v[90:93], v[186:189]
  v_mfma_f32_16x16x32_bf16 v[190:193], v[228:231], v[94:97], v[190:193]
  ds_read_b64 v[220:221], v234 offset:1488
  v_mfma_f32_16x16x32_bf16 v[194:197], v[230:233], v[94:97], v[194:197]
  v_mfma_f32_16x16x32_bf16 v[174:177], v[198:201], v[102:105], v[174:177]
  s_waitcnt lgkmcnt(3)
  s_barrier
  v_mfma_f32_16x16x32_bf16 v[178:181], v[200:203], v[102:105], v[178:181]
  ds_read_b64 v[222:223], v234 offset:2048
  v_mfma_f32_16x16x32_bf16 v[182:185], v[198:201], v[106:109], v[182:185]
  ds_read_b64 v[224:225], v234 offset:2056
  v_mfma_f32_16x16x32_bf16 v[186:189], v[200:203], v[106:109], v[186:189]
  ds_read_b64 v[226:227], v234 offset:2064
  v_mfma_f32_16x16x32_bf16 v[190:193], v[198:201], v[110:113], v[190:193]
  s_mov_b32 s12, s66
  s_mov_b32 s13, s67
  s_mov_b32 s14, 0x100
  s_mov_b32 s15, 0x20000
  buffer_load_dword v10, off, s[12:15], 0 sc1
  s_lshl_b32 s76, s72, 15
  s_lshl_b32 s77, s95, 8
  s_add_u32 s76, s76, s77
  s_lshl_b32 s77, s72, 13
  v_mfma_f32_16x16x32_bf16 v[194:197], v[200:203], v[110:113], v[194:197]
  s_add_u32 m0, s77, 98304
  s_add_u32 s78, s76, 0
  buffer_load_dwordx4 v11, s[20:23], s78 offen lds
  v_mfma_f32_16x16x32_bf16 v[174:177], v[204:207], v[118:121], v[174:177]
  ds_read_b64 v[228:229], v234 offset:2112
  v_mfma_f32_16x16x32_bf16 v[178:181], v[206:209], v[118:121], v[178:181]
  ds_read_b64 v[230:231], v234 offset:2120
  v_mfma_f32_16x16x32_bf16 v[182:185], v[204:207], v[122:125], v[182:185]
  v_mfma_f32_16x16x32_bf16 v[186:189], v[206:209], v[122:125], v[186:189]
  ds_read_b64 v[232:233], v234 offset:2128
  v_mfma_f32_16x16x32_bf16 v[190:193], v[204:207], v[126:129], v[190:193]
  s_add_u32 m0, s77, 99328
  s_add_u32 s78, s76, 4096
  buffer_load_dwordx4 v11, s[20:23], s78 offen lds
  v_mfma_f32_16x16x32_bf16 v[194:197], v[206:209], v[126:129], v[194:197]
  v_mfma_f32_16x16x32_bf16 v[174:177], v[210:213], v[134:137], v[174:177]
  ds_read_b64 v[198:199], v234 offset:2176
  v_mfma_f32_16x16x32_bf16 v[178:181], v[212:215], v[134:137], v[178:181]
  ds_read_b64 v[200:201], v234 offset:2184
  v_mfma_f32_16x16x32_bf16 v[182:185], v[210:213], v[138:141], v[182:185]
  v_mfma_f32_16x16x32_bf16 v[186:189], v[212:215], v[138:141], v[186:189]
  ds_read_b64 v[202:203], v234 offset:2192
  v_mfma_f32_16x16x32_bf16 v[190:193], v[210:213], v[142:145], v[190:193]
  s_add_u32 m0, s77, 100352
  s_add_u32 s78, s76, 8192
  buffer_load_dwordx4 v11, s[20:23], s78 offen lds
  v_mfma_f32_16x16x32_bf16 v[194:197], v[212:215], v[142:145], v[194:197]
  s_waitcnt lgkmcnt(9)
  v_mfma_f32_16x16x32_bf16 v[174:177], v[216:219], v[150:153], v[174:177]
  ds_read_b64 v[204:205], v234 offset:2240
  v_mfma_f32_16x16x32_bf16 v[178:181], v[218:221], v[150:153], v[178:181]
  ds_read_b64 v[206:207], v234 offset:2248
  v_mfma_f32_16x16x32_bf16 v[182:185], v[216:219], v[154:157], v[182:185]
  v_mfma_f32_16x16x32_bf16 v[186:189], v[218:221], v[154:157], v[186:189]
  ds_read_b64 v[208:209], v234 offset:2256
  v_mfma_f32_16x16x32_bf16 v[190:193], v[216:219], v[158:161], v[190:193]
  s_add_u32 m0, s77, 101376
  s_add_u32 s78, s76, 12288
  buffer_load_dwordx4 v11, s[20:23], s78 offen lds
  v_mfma_f32_16x16x32_bf16 v[194:197], v[218:221], v[158:161], v[194:197]
  s_waitcnt lgkmcnt(9)
  v_mfma_f32_16x16x32_bf16 v[182:185], v[222:225], v[38:41], v[182:185]
  ds_read_b64 v[210:211], v234 offset:2304
  v_mfma_f32_16x16x32_bf16 v[186:189], v[224:227], v[38:41], v[186:189]
  ds_read_b64 v[212:213], v234 offset:2312
  v_mfma_f32_16x16x32_bf16 v[190:193], v[222:225], v[42:45], v[190:193]
  ds_read_b64 v[214:215], v234 offset:2320
  v_mfma_f32_16x16x32_bf16 v[194:197], v[224:227], v[42:45], v[194:197]
  s_add_u32 m0, s77, 102400
  s_add_u32 s78, s76, 16384
  buffer_load_dwordx4 v11, s[20:23], s78 offen lds
  s_waitcnt lgkmcnt(9)
  v_mfma_f32_16x16x32_bf16 v[182:185], v[228:231], v[54:57], v[182:185]
  ds_read_b64 v[216:217], v234 offset:2368
  ds_read_b64 v[218:219], v234 offset:2376
  ds_read_b64 v[220:221], v234 offset:2384
  v_mfma_f32_16x16x32_bf16 v[186:189], v[230:233], v[54:57], v[186:189]
  s_waitcnt vmcnt(6)
  ds_write_b64 v7, v[24:25] offset:1656
  s_mov_b64 exec, 7
  ds_write_b64 v7, v[26:27] offset:1632
  s_mov_b64 exec, -1
  v_mfma_f32_16x16x32_bf16 v[190:193], v[228:231], v[58:61], v[190:193]
  ds_read_b64_tr_b16 v[28:29], v8 offset:1656
  ds_read_b64_tr_b16 v[30:31], v8 offset:1632
  ds_read_b64_tr_b16 v[32:33], v8 offset:1640
  v_mfma_f32_16x16x32_bf16 v[194:197], v[230:233], v[58:61], v[194:197]
  ds_read_b64_tr_b16 v[34:35], v8 offset:1648
  s_add_u32 m0, s77, 103424
  s_add_u32 s78, s76, 20480
  buffer_load_dwordx4 v11, s[20:23], s78 offen lds
  s_waitcnt lgkmcnt(15)
  v_mfma_f32_16x16x32_bf16 v[182:185], v[198:201], v[70:73], v[182:185]
  ds_read_b64 v[222:223], v234 offset:2432
  ds_read_b64 v[224:225], v234 offset:2440
  v_mfma_f32_16x16x32_bf16 v[186:189], v[200:203], v[70:73], v[186:189]
  ds_read_b64 v[226:227], v234 offset:2448
  s_waitcnt lgkmcnt(3)
  ds_write_b64 v9, v[28:29] offset:3080
  v_mfma_f32_16x16x32_bf16 v[190:193], v[198:201], v[74:77], v[190:193]
  ds_write_b64 v9, v[30:31] offset:7344
  ds_write_b64 v9, v[32:33] offset:11616
  v_mfma_f32_16x16x32_bf16 v[194:197], v[200:203], v[74:77], v[194:197]
  ds_write_b64 v9, v[34:35] offset:15888
  s_add_u32 m0, s77, 104448
  s_add_u32 s78, s76, 24576
  buffer_load_dwordx4 v11, s[20:23], s78 offen lds
  v_mfma_f32_16x16x32_bf16 v[182:185], v[204:207], v[86:89], v[182:185]
  ds_read_b64 v[228:229], v234 offset:2496
  v_mfma_f32_16x16x32_bf16 v[186:189], v[206:209], v[86:89], v[186:189]
  ds_read_b64 v[230:231], v234 offset:2504
  v_mfma_f32_16x16x32_bf16 v[190:193], v[204:207], v[90:93], v[190:193]
  ds_read_b64 v[232:233], v234 offset:2512
  v_mfma_f32_16x16x32_bf16 v[194:197], v[206:209], v[90:93], v[194:197]
  s_add_u32 m0, s77, 105472
  s_add_u32 s78, s76, 28672
  buffer_load_dwordx4 v11, s[20:23], s78 offen lds
  v_mfma_f32_16x16x32_bf16 v[182:185], v[210:213], v[102:105], v[182:185]
  s_waitcnt lgkmcnt(3)
  s_barrier
  ds_read_b64 v[198:199], v234 offset:3072
  v_mfma_f32_16x16x32_bf16 v[186:189], v[212:215], v[102:105], v[186:189]
  ds_read_b64 v[200:201], v234 offset:3080
  v_mfma_f32_16x16x32_bf16 v[190:193], v[210:213], v[106:109], v[190:193]
  ds_read_b64 v[202:203], v234 offset:3088
  s_lshl_b32 s76, s94, 15
  s_lshl_b32 s77, s72, 12
  s_add_u32 s76, s76, s77
  v_mfma_f32_16x16x32_bf16 v[194:197], v[212:215], v[106:109], v[194:197]
  buffer_load_dwordx4 v[12:15], v235, s[4:7], s76 offen offset:0
  v_mfma_f32_16x16x32_bf16 v[182:185], v[216:219], v[118:121], v[182:185]
  ds_read_b64 v[204:205], v234 offset:3136
  v_mfma_f32_16x16x32_bf16 v[186:189], v[218:221], v[118:121], v[186:189]
  ds_read_b64 v[206:207], v234 offset:3144
  v_mfma_f32_16x16x32_bf16 v[190:193], v[216:219], v[122:125], v[190:193]
  ds_read_b64 v[208:209], v234 offset:3152
  v_mfma_f32_16x16x32_bf16 v[194:197], v[218:221], v[122:125], v[194:197]
  buffer_load_dwordx4 v[16:19], v235, s[4:7], s76 offen offset:1024
  v_mfma_f32_16x16x32_bf16 v[182:185], v[222:225], v[134:137], v[182:185]
  ds_read_b64 v[210:211], v234 offset:3200
  v_mfma_f32_16x16x32_bf16 v[186:189], v[224:227], v[134:137], v[186:189]
  ds_read_b64 v[212:213], v234 offset:3208
  v_mfma_f32_16x16x32_bf16 v[190:193], v[222:225], v[138:141], v[190:193]
  ds_read_b64 v[214:215], v234 offset:3216
  v_mfma_f32_16x16x32_bf16 v[194:197], v[224:227], v[138:141], v[194:197]
  buffer_load_dwordx4 v[20:23], v235, s[4:7], s76 offen offset:2048
  s_waitcnt lgkmcnt(9)
  v_mfma_f32_16x16x32_bf16 v[182:185], v[228:231], v[150:153], v[182:185]
  ds_read_b64 v[216:217], v234 offset:3264
  v_mfma_f32_16x16x32_bf16 v[186:189], v[230:233], v[150:153], v[186:189]
  ds_read_b64 v[218:219], v234 offset:3272
  v_mfma_f32_16x16x32_bf16 v[190:193], v[228:231], v[154:157], v[190:193]
  ds_read_b64 v[220:221], v234 offset:3280
  v_mfma_f32_16x16x32_bf16 v[194:197], v[230:233], v[154:157], v[194:197]
  buffer_load_dwordx4 v[24:27], v235, s[4:7], s76 offen offset:3072
  s_waitcnt lgkmcnt(9)
  v_mfma_f32_16x16x32_bf16 v[190:193], v[198:201], v[38:41], v[190:193]
  ds_read_b64 v[222:223], v234 offset:3328
  ds_read_b64 v[224:225], v234 offset:3336
  v_mfma_f32_16x16x32_bf16 v[194:197], v[200:203], v[38:41], v[194:197]
  ds_read_b64 v[226:227], v234 offset:3344
  buffer_load_dwordx4 v[28:31], v235, s[24:27], 0 offen
  s_waitcnt lgkmcnt(9)
  v_mfma_f32_16x16x32_bf16 v[190:193], v[204:207], v[54:57], v[190:193]
  ds_read_b64 v[228:229], v234 offset:3392
  ds_read_b64 v[230:231], v234 offset:3400
  v_mfma_f32_16x16x32_bf16 v[194:197], v[206:209], v[54:57], v[194:197]
  ds_read_b64 v[232:233], v234 offset:3408
  s_waitcnt lgkmcnt(9)
  v_mfma_f32_16x16x32_bf16 v[190:193], v[210:213], v[70:73], v[190:193]
  ds_read_b64 v[198:199], v234 offset:3456
  ds_read_b64 v[200:201], v234 offset:3464
  v_mfma_f32_16x16x32_bf16 v[194:197], v[212:215], v[70:73], v[194:197]
  ds_read_b64 v[202:203], v234 offset:3472
  s_waitcnt lgkmcnt(9)
  v_mfma_f32_16x16x32_bf16 v[190:193], v[216:219], v[86:89], v[190:193]
  ds_read_b64 v[204:205], v234 offset:3520
  ds_read_b64 v[206:207], v234 offset:3528
  v_mfma_f32_16x16x32_bf16 v[194:197], v[218:221], v[86:89], v[194:197]
  ds_read_b64 v[208:209], v234 offset:3536
  s_waitcnt lgkmcnt(9)
  v_mfma_f32_16x16x32_bf16 v[190:193], v[222:225], v[102:105], v[190:193]
  v_mfma_f32_16x16x32_bf16 v[194:197], v[224:227], v[102:105], v[194:197]
  s_waitcnt lgkmcnt(6)
  v_mfma_f32_16x16x32_bf16 v[190:193], v[228:231], v[118:121], v[190:193]
  v_mfma_f32_16x16x32_bf16 v[194:197], v[230:233], v[118:121], v[194:197]
  s_waitcnt lgkmcnt(3)
  v_mfma_f32_16x16x32_bf16 v[190:193], v[198:201], v[134:137], v[190:193]
  v_mfma_f32_16x16x32_bf16 v[194:197], v[200:203], v[134:137], v[194:197]
  s_waitcnt lgkmcnt(0)
  v_mfma_f32_16x16x32_bf16 v[190:193], v[204:207], v[150:153], v[190:193]
  v_mfma_f32_16x16x32_bf16 v[194:197], v[206:209], v[150:153], v[194:197]
  s_mul_i32 s76, s74, 17120
  s_lshl_b32 s77, s75, 10
  s_add_u32 s76, s76, s77
  v_lshl_add_u32 v5, v1, 4, s76
  s_mul_i32 s76, s74, 17120
  s_xor_b32 s77, s77, 1024
  s_add_u32 s76, s76, s77
  v_lshl_add_u32 v4, v1, 4, s76
  s_cmp_eq_u32 s75, 1
  s_cbranch_scc1 C_x1
  ds_write_b128 v5, v[182:185] offset:0
  ds_write_b128 v5, v[186:189] offset:4272
  ds_write_b128 v5, v[190:193] offset:8544
  ds_write_b128 v5, v[194:197] offset:12816
  s_branch C_x2
C_x1:
  ds_write_b128 v5, v[166:169] offset:0
  ds_write_b128 v5, v[170:173] offset:4272
  ds_write_b128 v5, v[174:177] offset:8544
  ds_write_b128 v5, v[178:181] offset:12816
  v_mov_b32 v166, v182
  v_mov_b32 v167, v183
  v_mov_b32 v168, v184
  v_mov_b32 v169, v185
  v_mov_b32 v170, v186
  v_mov_b32 v171, v187
  v_mov_b32 v172, v188
  v_mov_b32 v173, v189
  v_mov_b32 v174, v190
  v_mov_b32 v175, v191
  v_mov_b32 v176, v192
  v_mov_b32 v177, v193
  v_mov_b32 v178, v194
  v_mov_b32 v179, v195
  v_mov_b32 v180, v196
  v_mov_b32 v181, v197
C_x2:
  v_lshlrev_b32 v5, 5, v2
  v_lshl_add_u32 v5, v3, 3, v5
  s_mul_i32 s76, s74, 4160
  s_lshl_b32 s77, s75, 10
  s_add_u32 s76, s76, s77
  s_add_u32 s76, s76, 68480
  v_add_u32 v5, s76, v5
  s_waitcnt lgkmcnt(0)
  s_barrier
  ds_read_b128 v[198:201], v4 offset:0
  ds_read_b128 v[202:205], v4 offset:4272
  ds_read_b128 v[206:209], v4 offset:8544
  ds_read_b128 v[210:213], v4 offset:12816
  v_bfe_u32 v4, v1, 2, 2
  s_movk_i32 s76, 4160
  v_mul_u32_u24 v4, s76, v4
  v_lshl_add_u32 v4, v3, 5, v4
  v_and_b32 v234, 3, v1
  v_lshl_add_u32 v4, v234, 3, v4
  s_lshl_b32 s76, s72, 8
  s_add_u32 s76, s76, 68480
  v_add_u32 v4, s76, v4
  s_waitcnt lgkmcnt(0)
  v_pk_add_f32 v[166:167], v[166:167], v[198:199]
  v_pk_add_f32 v[168:169], v[168:169], v[200:201]
  v_pk_add_f32 v[170:171], v[170:171], v[202:203]
  v_pk_add_f32 v[172:173], v[172:173], v[204:205]
  v_pk_add_f32 v[174:175], v[174:175], v[206:207]
  v_pk_add_f32 v[176:177], v[176:177], v[208:209]
  v_pk_add_f32 v[178:179], v[178:179], v[210:211]
  v_pk_add_f32 v[180:181], v[180:181], v[212:213]
  v_cvt_pk_bf16_f32 v214, v166, v168
  v_cvt_pk_bf16_f32 v215, v170, v172
  ds_write_b64 v5, v[214:215] offset:0
  v_cvt_pk_bf16_f32 v216, v167, v169
  v_cvt_pk_bf16_f32 v217, v171, v173
  ds_write_b64 v5, v[216:217] offset:2048
  v_cvt_pk_bf16_f32 v218, v174, v176
  v_cvt_pk_bf16_f32 v219, v178, v180
  ds_write_b64 v5, v[218:219] offset:512
  v_cvt_pk_bf16_f32 v220, v175, v177
  v_cvt_pk_bf16_f32 v221, v179, v181
  ds_write_b64 v5, v[220:221] offset:2560
  v_lshlrev_b32 v5, 4, v1
  s_lshl_b32 s76, s73, 14
  s_lshl_b32 s77, s72, 11
  s_add_u32 s76, s76, s77
  s_waitcnt lgkmcnt(0)
  s_barrier
  ds_read_b64_tr_b16 v[38:39], v4 offset:0
  ds_read_b64_tr_b16 v[40:41], v4 offset:2048
  ds_read_b64_tr_b16 v[42:43], v4 offset:128
  ds_read_b64_tr_b16 v[44:45], v4 offset:2176
  s_waitcnt vmcnt(0)
  s_waitcnt lgkmcnt(2)
  buffer_store_dwordx4 v[38:41], v5, s[8:11], s76 offen offset:0 sc1
  s_waitcnt lgkmcnt(0)
  buffer_store_dwordx4 v[42:45], v5, s[8:11], s76 offen offset:1024 sc1
  v_dot2_f32_bf16 v32, v12, v28, 0
  v_dot2_f32_bf16 v32, v13, v29, v32
  v_dot2_f32_bf16 v32, v14, v30, v32
  v_dot2_f32_bf16 v32, v15, v31, v32
  v_dot2_f32_bf16 v33, v16, v28, 0
  v_dot2_f32_bf16 v33, v17, v29, v33
  v_dot2_f32_bf16 v33, v18, v30, v33
  v_dot2_f32_bf16 v33, v19, v31, v33
  v_dot2_f32_bf16 v34, v20, v28, 0
  v_dot2_f32_bf16 v34, v21, v29, v34
  v_dot2_f32_bf16 v34, v22, v30, v34
  v_dot2_f32_bf16 v34, v23, v31, v34
  v_dot2_f32_bf16 v35, v24, v28, 0
  v_dot2_f32_bf16 v35, v25, v29, v35
  v_dot2_f32_bf16 v35, v26, v30, v35
  v_dot2_f32_bf16 v35, v27, v31, v35
  v_permlane32_swap_b32 v32, v33
  s_nop 1
  v_permlane32_swap_b32 v34, v35
  v_add_f32 v32, v32, v33
  v_add_f32 v34, v34, v35
  s_nop 1
  v_permlane16_swap_b32 v32, v34
  v_add_f32 v32, v32, v34
  s_nop 1
  v_add_f32_dpp v32, v32, v32 row_ror:8 row_mask:0xf bank_mask:0xf
  s_nop 1
  v_add_f32_dpp v32, v32, v32 row_ror:4 row_mask:0xf bank_mask:0xf
  s_nop 1
  v_add_f32_dpp v32, v32, v32 row_ror:2 row_mask:0xf bank_mask:0xf
  s_nop 1
  v_add_f32_dpp v32, v32, v32 row_ror:1 row_mask:0xf bank_mask:0xf
  v_cvt_pk_bf16_f32 v32, v32, v32
  v_and_b32 v32, 0xffff0000, v32
  v_mul_f32 v32, 0xbfb8aa3b, v32
  v_exp_f32 v32, v32
  s_nop 0
  v_add_f32 v32, 1.0, v32
  v_rcp_f32 v32, v32
  s_nop 0
  v_cvt_pk_bf16_f32 v32, v32, v32
  v_and_b32 v250, 0xffff0000, v32
  s_lshl_b32 s93, s72, 4
  s_or_b32 s93, s93, 256
  s_mov_b32 s77, 0
C_z_a:
  v_readfirstlane_b32 s76, v10
  s_nop 1
  s_cmp_ge_u32 s76, 8
  s_cbranch_scc1 C_z_b
  buffer_load_dword v10, off, s[12:15], 0 sc1
  s_add_u32 s77, s77, 1
  s_cmp_ge_u32 s77, 65536
  s_cbranch_scc1 K_end
  s_waitcnt vmcnt(0)
  s_branch C_z_a
C_z_b:
  s_lshl_b32 s3, s72, 7
  s_add_u32 s3, s3, s73
  s_lshl_b32 s3, s3, 2
  s_add_u32 s3, s3, 102400
  s_waitcnt vmcnt(0)
  v_mov_b32 v2, 1
  s_mov_b64 exec, 1
  buffer_store_dword v2, off, s[16:19], s3 sc1
  s_mov_b64 exec, -1
  s_barrier
  s_mov_b32 s92, 1
  s_mov_b32 s70, 98304
  s_mov_b32 s71, 65536
K_final:
  v_lshlrev_b32 v9, 4, v1
  s_lshl_b32 s86, s95, 1
  s_add_u32 s86, s86, s94
  s_add_u32 s86, s86, s72
  s_and_b32 s86, s86, 7
  s_add_u32 s8, s68, 0x600000
  s_addc_u32 s9, s69, 0
  s_mov_b32 s10, 0x1b000
  s_mov_b32 s11, 0x20000
  s_mov_b32 s4, s68
  s_mov_b32 s5, s69
  s_mov_b32 s6, 0x400000
  s_mov_b32 s7, 0x20000
  s_add_u32 s16, s68, 0x400000
  s_addc_u32 s17, s69, 0
  s_mov_b32 s18, 0x200000
  s_mov_b32 s19, 0x20000
  s_mov_b32 s24, s64
  s_mov_b32 s25, s65
  s_mov_b32 s26, 0x200000
  s_mov_b32 s27, 0x20000
  v_and_b32 v2, 15, v1
  v_lshrrev_b32 v3, 4, v1
  v_lshrrev_b32 v5, 5, v1
  v_bfe_u32 v4, v1, 2, 2
  v_lshl_add_u32 v7, v5, 3, v4
  v_lshlrev_b32 v7, 8, v7
  s_and_b32 s76, s72, 3
  v_xor_b32 v4, s76, v4
  v_lshl_add_u32 v7, v4, 6, v7
  v_and_b32 v4, 1, v3
  v_lshl_add_u32 v7, v4, 5, v7
  v_and_b32 v4, 3, v1
  v_lshl_add_u32 v7, v4, 3, v7
  s_cmp_lt_u32 s72, 4
  s_cselect_b32 s76, s70, 0
  v_add_u32 v7, s76, v7
  v_and_b32 v4, 31, v1
  v_lshlrev_b32 v11, 3, v4
  v_lshl_add_u32 v11, v5, 14, v11
  s_and_b32 s76, s72, 3
  s_lshl_b32 s76, s76, 3
  s_lshr_b32 s77, s72, 2
  s_lshl_b32 s77, s77, 2
  s_add_u32 s76, s76, s77
  s_lshl_b32 s77, s95, 5
  s_add_u32 s84, s76, s77
  s_mov_b32 s28, s42
  s_mov_b32 s29, s43
  s_mov_b32 s30, 0x80000
  s_mov_b32 s31, 0x20000
  v_lshrrev_b32 v4, 4, v1
  v_lshlrev_b32 v10, 2, v4
  v_xor_b32 v10, v10, v1
  v_and_b32 v10, 15, v10
  v_lshlrev_b32 v10, 4, v10
  v_lshl_add_u32 v10, v4, 10, v10
  s_lshl_b32 s88, s94, 3
  s_add_u32 s88, s88, s86
  s_lshl_b32 s88, s88, 12
  s_lshr_b32 s77, s94, 2
  s_lshl_b32 s77, s77, 10
  s_add_u32 s77, s77, 86016
  v_and_b32 v4, 7, v1
  v_lshl_add_u32 v12, v4, 7, s77
  v_cmp_eq_u32 vcc, s3, v12
  s_nop 1
  s_mov_b32 s80, vcc_lo
  s_lshr_b32 s85, s94, 3
  s_lshl_b32 s85, s85, 7
  s_add_u32 s85, s85, s84
  s_lshl_b32 s85, s85, 2
  s_add_u32 s85, s85, 102400
  s_lshl_b32 s76, s86, 12
  s_add_u32 s76, s76, s71
  v_add_u32 v8, s76, v9
  s_cmp_eq_u32 s72, 0
  s_cbranch_scc1 F_g2
  s_lshl_b32 s76, s72, 14
  s_lshl_b32 s77, s95, 8
  s_add_u32 s76, s76, s77
  s_lshl_b32 s77, s72, 12
  s_cmp_eq_u32 s92, 2
  s_cbranch_scc1 F_la_g
  s_add_u32 m0, s77, 0
  s_add_u32 s78, s76, 262144
  buffer_load_dwordx4 v10, s[28:31], s78 offen lds
  s_add_u32 m0, s77, 1024
  s_add_u32 s78, s76, 266240
  buffer_load_dwordx4 v10, s[28:31], s78 offen lds
  s_add_u32 m0, s77, 2048
  s_add_u32 s78, s76, 270336
  buffer_load_dwordx4 v10, s[28:31], s78 offen lds
  s_add_u32 m0, s77, 3072
  s_add_u32 s78, s76, 274432
  buffer_load_dwordx4 v10, s[28:31], s78 offen lds
  s_add_u32 m0, s77, 32768
  s_add_u32 s78, s76, 393216
  buffer_load_dwordx4 v10, s[28:31], s78 offen lds
  s_add_u32 m0, s77, 33792
  s_add_u32 s78, s76, 397312
  buffer_load_dwordx4 v10, s[28:31], s78 offen lds
  s_add_u32 m0, s77, 34816
  s_add_u32 s78, s76, 401408
  buffer_load_dwordx4 v10, s[28:31], s78 offen lds
  s_add_u32 m0, s77, 35840
  s_add_u32 s78, s76, 405504
  buffer_load_dwordx4 v10, s[28:31], s78 offen lds
  s_branch F_la_e
F_la_g:
  s_add_u32 s77, s77, s70
  s_add_u32 m0, s77, 32768
  s_add_u32 s78, s76, 131072
  buffer_load_dwordx4 v10, s[28:31], s78 offen lds
  s_add_u32 m0, s77, 33792
  s_add_u32 s78, s76, 135168
  buffer_load_dwordx4 v10, s[28:31], s78 offen lds
  s_add_u32 m0, s77, 34816
  s_add_u32 s78, s76, 139264
  buffer_load_dwordx4 v10, s[28:31], s78 offen lds
  s_add_u32 m0, s77, 35840
  s_add_u32 s78, s76, 143360
  buffer_load_dwordx4 v10, s[28:31], s78 offen lds
F_la_e:
  s_mov_b32 s92, 0
  s_branch F_g1
F_g2:
  s_mov_b32 s78, 0
F_p1_a:
  s_mov_b64 exec, 0xff
  buffer_load_dword v18, v12, s[8:11], 0 offen sc1
  s_mov_b64 exec, -1
  s_add_u32 s78, s78, 1
  s_cmp_ge_u32 s78, 65536
  s_cbranch_scc1 K_end
  s_waitcnt vmcnt(0)
  v_cmp_eq_u32 vcc, 1, v18
  s_nop 1
  s_or_b32 s79, vcc_lo, s80
  s_and_b32 s79, s79, 0xff
  s_cmp_eq_u32 s79, 0xff
  s_cbranch_scc1 F_p1_b
  s_sleep 2
  s_branch F_p1_a
F_p1_b:
F_g1:
  s_barrier
  buffer_load_dwordx4 v[58:61], v9, s[4:7], s88 offen offset:0 sc1
  buffer_load_dwordx4 v[62:65], v9, s[4:7], s88 offen offset:1024 sc1
  buffer_load_dwordx4 v[66:69], v9, s[4:7], s88 offen offset:2048 sc1
  buffer_load_dwordx4 v[70:73], v9, s[4:7], s88 offen offset:3072 sc1
  buffer_load_dwordx4 v[90:93], off, s[8:11], s85 sc1
  s_cmp_eq_u32 s92, 0
  s_cbranch_scc1 F_l5
  s_lshl_b32 s76, s72, 14
  s_lshl_b32 s77, s95, 8
  s_add_u32 s76, s76, s77
  s_lshl_b32 s77, s72, 12
  s_cmp_eq_u32 s92, 2
  s_cbranch_scc1 F_lb_g
  s_add_u32 m0, s77, 0
  s_add_u32 s78, s76, 262144
  buffer_load_dwordx4 v10, s[28:31], s78 offen lds
  s_add_u32 m0, s77, 1024
  s_add_u32 s78, s76, 266240
  buffer_load_dwordx4 v10, s[28:31], s78 offen lds
  s_add_u32 m0, s77, 2048
  s_add_u32 s78, s76, 270336
  buffer_load_dwordx4 v10, s[28:31], s78 offen lds
  s_add_u32 m0, s77, 3072
  s_add_u32 s78, s76, 274432
  buffer_load_dwordx4 v10, s[28:31], s78 offen lds
  s_add_u32 m0, s77, 32768
  s_add_u32 s78, s76, 393216
  buffer_load_dwordx4 v10, s[28:31], s78 offen lds
  s_add_u32 m0, s77, 33792
  s_add_u32 s78, s76, 397312
  buffer_load_dwordx4 v10, s[28:31], s78 offen lds
  s_add_u32 m0, s77, 34816
  s_add_u32 s78, s76, 401408
  buffer_load_dwordx4 v10, s[28:31], s78 offen lds
  s_add_u32 m0, s77, 35840
  s_add_u32 s78, s76, 405504
  buffer_load_dwordx4 v10, s[28:31], s78 offen lds
  s_branch F_lb_e
F_lb_g:
  s_add_u32 s77, s77, s70
  s_add_u32 m0, s77, 32768
  s_add_u32 s78, s76, 131072
  buffer_load_dwordx4 v10, s[28:31], s78 offen lds
  s_add_u32 m0, s77, 33792
  s_add_u32 s78, s76, 135168
  buffer_load_dwordx4 v10, s[28:31], s78 offen lds
  s_add_u32 m0, s77, 34816
  s_add_u32 s78, s76, 139264
  buffer_load_dwordx4 v10, s[28:31], s78 offen lds
  s_add_u32 m0, s77, 35840
  s_add_u32 s78, s76, 143360
  buffer_load_dwordx4 v10, s[28:31], s78 offen lds
F_lb_e:
F_l5:
  s_waitcnt vmcnt(0)
  ds_write_b128 v8, v[58:61] offset:0
  ds_write_b128 v8, v[62:65] offset:1024
  ds_write_b128 v8, v[66:69] offset:2048
  ds_write_b128 v8, v[70:73] offset:3072
  v_and_b32 v90, v90, v91
  v_and_b32 v92, v92, v93
  v_and_b32 v90, v90, v92
  s_nop 0
  v_readfirstlane_b32 s79, v90
  s_nop 1
  s_cmp_eq_u32 s79, 1
  s_cselect_b32 s81, 1, 0
  s_lshl_b32 s82, s84, 14
  s_lshl_b32 s77, s94, 8
  s_add_u32 s82, s82, s77
  s_add_u32 s83, s82, 32768
  s_cmp_eq_u32 s81, 0
  s_cbranch_scc1 F_nob1
  buffer_load_dwordx2 v[90:91], v11, s[16:19], s82 offen sc1
  buffer_load_dwordx2 v[92:93], v11, s[16:19], s83 offen sc1
F_nob1:
  s_lshr_b32 s76, s72, 2
  s_lshl_b32 s76, s76, 14
  s_add_u32 s76, s76, s71
  v_add_u32 v4, s76, v9
  s_waitcnt lgkmcnt(0)
  s_barrier
  ds_read_b128 v[130:133], v4 offset:0
  ds_read_b64_tr_b16 v[162:163], v7 offset:0
  ds_read_b64_tr_b16 v[164:165], v7 offset:1024
  ds_read_b128 v[134:137], v4 offset:1024
  ds_read_b64_tr_b16 v[166:167], v7 offset:4096
  ds_read_b64_tr_b16 v[168:169], v7 offset:5120
  ds_read_b128 v[138:141], v4 offset:2048
  ds_read_b64_tr_b16 v[170:171], v7 offset:8192
  ds_read_b64_tr_b16 v[172:173], v7 offset:9216
  ds_read_b128 v[142:145], v4 offset:3072
  ds_read_b64_tr_b16 v[174:175], v7 offset:12288
  ds_read_b64_tr_b16 v[176:177], v7 offset:13312
  ds_read_b128 v[146:149], v4 offset:4096
  ds_read_b64_tr_b16 v[178:179], v7 offset:16384
  ds_read_b64_tr_b16 v[180:181], v7 offset:17408
  s_waitcnt lgkmcnt(12)
  v_mfma_f32_32x32x16_bf16 v[210:225], v[162:165], v[130:133], 0
  ds_read_b128 v[150:153], v4 offset:5120
  ds_read_b64_tr_b16 v[182:183], v7 offset:20480
  ds_read_b64_tr_b16 v[184:185], v7 offset:21504
  s_waitcnt lgkmcnt(12)
  v_mfma_f32_32x32x16_bf16 v[210:225], v[166:169], v[134:137], v[210:225]
  ds_read_b128 v[154:157], v4 offset:6144
  ds_read_b64_tr_b16 v[186:187], v7 offset:24576
  ds_read_b64_tr_b16 v[188:189], v7 offset:25600
  s_waitcnt lgkmcnt(12)
  v_mfma_f32_32x32x16_bf16 v[210:225], v[170:173], v[138:141], v[210:225]
  ds_read_b128 v[158:161], v4 offset:7168
  ds_read_b64_tr_b16 v[190:191], v7 offset:28672
  ds_read_b64_tr_b16 v[192:193], v7 offset:29696
  s_waitcnt lgkmcnt(12)
  v_mfma_f32_32x32x16_bf16 v[210:225], v[174:177], v[142:145], v[210:225]
  ds_read_b128 v[130:133], v4 offset:8192
  ds_read_b64_tr_b16 v[162:163], v7 offset:32768
  ds_read_b64_tr_b16 v[164:165], v7 offset:33792
  s_waitcnt lgkmcnt(12)
  v_mfma_f32_32x32x16_bf16 v[210:225], v[178:181], v[146:149], v[210:225]
  ds_read_b128 v[134:137], v4 offset:9216
  ds_read_b64_tr_b16 v[166:167], v7 offset:36864
  ds_read_b64_tr_b16 v[168:169], v7 offset:37888
  s_waitcnt lgkmcnt(12)
  v_mfma_f32_32x32x16_bf16 v[210:225], v[182:185], v[150:153], v[210:225]
  ds_read_b128 v[138:141], v4 offset:10240
  ds_read_b64_tr_b16 v[170:171], v7 offset:40960
  ds_read_b64_tr_b16 v[172:173], v7 offset:41984
  s_waitcnt lgkmcnt(12)
  v_mfma_f32_32x32x16_bf16 v[210:225], v[186:189], v[154:157], v[210:225]
  ds_read_b128 v[142:145], v4 offset:11264
  ds_read_b64_tr_b16 v[174:175], v7 offset:45056
  ds_read_b64_tr_b16 v[176:177], v7 offset:46080
  s_waitcnt lgkmcnt(12)
  v_mfma_f32_32x32x16_bf16 v[210:225], v[190:193], v[158:161], v[210:225]
  ds_read_b128 v[146:149], v4 offset:12288
  ds_read_b64_tr_b16 v[178:179], v7 offset:49152
  ds_read_b64_tr_b16 v[180:181], v7 offset:50176
  s_waitcnt lgkmcnt(12)
  v_mfma_f32_32x32x16_bf16 v[210:225], v[162:165], v[130:133], v[210:225]
  ds_read_b128 v[150:153], v4 offset:13312
  ds_read_b64_tr_b16 v[182:183], v7 offset:53248
  ds_read_b64_tr_b16 v[184:185], v7 offset:54272
  s_waitcnt lgkmcnt(12)
  v_mfma_f32_32x32x16_bf16 v[210:225], v[166:169], v[134:137], v[210:225]
  ds_read_b128 v[154:157], v4 offset:14336
  ds_read_b64_tr_b16 v[186:187], v7 offset:57344
  ds_read_b64_tr_b16 v[188:189], v7 offset:58368
  s_waitcnt lgkmcnt(12)
  v_mfma_f32_32x32x16_bf16 v[210:225], v[170:173], v[138:141], v[210:225]
  ds_read_b128 v[158:161], v4 offset:15360
  ds_read_b64_tr_b16 v[190:191], v7 offset:61440
  ds_read_b64_tr_b16 v[192:193], v7 offset:62464
  s_waitcnt lgkmcnt(12)
  v_mfma_f32_32x32x16_bf16 v[210:225], v[174:177], v[142:145], v[210:225]
  s_waitcnt lgkmcnt(9)
  v_mfma_f32_32x32x16_bf16 v[210:225], v[178:181], v[146:149], v[210:225]
  s_waitcnt lgkmcnt(6)
  v_mfma_f32_32x32x16_bf16 v[210:225], v[182:185], v[150:153], v[210:225]
  s_waitcnt lgkmcnt(3)
  v_mfma_f32_32x32x16_bf16 v[210:225], v[186:189], v[154:157], v[210:225]
  s_waitcnt lgkmcnt(0)
  v_mfma_f32_32x32x16_bf16 v[210:225], v[190:193], v[158:161], v[210:225]
  s_barrier
  s_lshl_b32 s76, s72, 11
  s_add_u32 s76, s76, s71
  v_add_u32 v4, s76, v9
  v_xor_b32 v10, 8192, v4
  v_and_b32 v2, 1, v3
  v_lshlrev_b32 v2, 3, v2
  v_lshl_add_u32 v2, v5, 2, v2
  s_cmp_eq_u32 s93, -1
  s_cbranch_scc1 F_nog
  s_and_b32 s76, s93, 0xff
  s_add_u32 s76, s76, s71
  s_add_u32 s76, s76, 16384
  v_add_u32 v2, s76, v2
  ds_write_b32 v2, v250
  s_bitcmp1_b32 s93, 8
  s_cbranch_scc1 F_nog
  ds_write_b32 v2, v251 offset:16
F_nog:
  s_cmp_ge_u32 s72, 4
  s_cbranch_scc1 F_x1
  ds_write_b128 v4, v[218:221] offset:0
  ds_write_b128 v4, v[222:225] offset:1024
  s_branch F_x2
F_x1:
  ds_write_b128 v4, v[210:213] offset:0
  ds_write_b128 v4, v[214:217] offset:1024
  v_mov_b32 v210, v218
  v_mov_b32 v211, v219
  v_mov_b32 v212, v220
  v_mov_b32 v213, v221
  v_mov_b32 v214, v222
  v_mov_b32 v215, v223
  v_mov_b32 v216, v224
  v_mov_b32 v217, v225
F_x2:
  s_cmp_eq_u32 s81, 1
  s_cbranch_scc1 F_hasb
  s_mov_b32 s78, 0
F_p3_a:
  buffer_load_dwordx4 v[90:93], off, s[8:11], s85 sc1
  s_add_u32 s78, s78, 1
  s_cmp_ge_u32 s78, 65536
  s_cbranch_scc1 K_end
  s_waitcnt vmcnt(0)
  v_and_b32 v90, v90, v91
  v_and_b32 v92, v92, v93
  v_and_b32 v90, v90, v92
  s_nop 0
  v_readfirstlane_b32 s79, v90
  s_nop 1
  s_cmp_eq_u32 s79, 1
  s_cbranch_scc1 F_p3_b
  s_sleep 4
  s_branch F_p3_a
F_p3_b:
  buffer_load_dwordx2 v[90:91], v11, s[16:19], s82 offen sc1
  buffer_load_dwordx2 v[92:93], v11, s[16:19], s83 offen sc1
F_hasb:
  v_and_b32 v2, 31, v1
  v_lshlrev_b32 v3, 2, v2
  v_add_u32 v3, s71, v3
  v_lshlrev_b32 v2, 10, v2
  v_lshl_add_u32 v2, v5, 4, v2
  s_lshl_b32 s76, s94, 15
  s_lshl_b32 s77, s84, 3
  s_add_u32 s76, s76, s77
  s_waitcnt lgkmcnt(0)
  s_barrier
  ds_read_b32 v162, v3 offset:16384
  ds_read_b128 v[130:133], v10 offset:0
  ds_read_b128 v[134:137], v10 offset:1024
  s_waitcnt vmcnt(0)
  v_lshlrev_b32 v170, 16, v90
  v_and_b32 v171, 0xffff0000, v90
  v_lshlrev_b32 v172, 16, v91
  v_and_b32 v173, 0xffff0000, v91
  v_lshlrev_b32 v174, 16, v92
  v_and_b32 v175, 0xffff0000, v92
  v_lshlrev_b32 v176, 16, v93
  v_and_b32 v177, 0xffff0000, v93
  s_waitcnt lgkmcnt(2)
  v_sub_f32 v163, 1.0, v162
  v_cvt_pk_bf16_f32 v163, v163, v163
  v_and_b32 v163, 0xffff0000, v163
  v_pk_mul_f32 v[170:171], v[170:171], v[162:163] op_sel:[0,1] op_sel_hi:[1,1]
  v_pk_mul_f32 v[172:173], v[172:173], v[162:163] op_sel:[0,1] op_sel_hi:[1,1]
  v_pk_mul_f32 v[174:175], v[174:175], v[162:163] op_sel:[0,1] op_sel_hi:[1,1]
  v_pk_mul_f32 v[176:177], v[176:177], v[162:163] op_sel:[0,1] op_sel_hi:[1,1]
  s_waitcnt lgkmcnt(0)
  v_pk_add_f32 v[210:211], v[210:211], v[130:131]
  v_pk_add_f32 v[212:213], v[212:213], v[132:133]
  v_pk_add_f32 v[214:215], v[214:215], v[134:135]
  v_pk_add_f32 v[216:217], v[216:217], v[136:137]
  v_pk_fma_f32 v[210:211], v[210:211], v[162:163], v[170:171] op_sel:[0,0,0] op_sel_hi:[1,0,1]
  v_pk_fma_f32 v[212:213], v[212:213], v[162:163], v[172:173] op_sel:[0,0,0] op_sel_hi:[1,0,1]
  v_pk_fma_f32 v[214:215], v[214:215], v[162:163], v[174:175] op_sel:[0,0,0] op_sel_hi:[1,0,1]
  v_pk_fma_f32 v[216:217], v[216:217], v[162:163], v[176:177] op_sel:[0,0,0] op_sel_hi:[1,0,1]
  v_cvt_pk_bf16_f32 v138, v210, v211
  v_cvt_pk_bf16_f32 v139, v212, v213
  v_cvt_pk_bf16_f32 v140, v214, v215
  v_cvt_pk_bf16_f32 v141, v216, v217
  s_nop 0
  v_permlane32_swap_b32 v138, v140
  v_permlane32_swap_b32 v139, v141
  buffer_store_dwordx4 v[138:141], v2, s[24:27], s76 offen
  s_endpgm
K_end:
  s_endpgm
.section .rodata,"a"
.p2align 6
.amdhsa_kernel gated_mix__linear_kernel_hedgehog__ssm_conv_s4__prompt_kernel
  .amdhsa_next_free_vgpr 254
  .amdhsa_next_free_sgpr 100
  .amdhsa_accum_offset 256
  .amdhsa_group_segment_fixed_size 0
  .amdhsa_kernarg_size 136
  .amdhsa_user_sgpr_count 2
  .amdhsa_user_sgpr_kernarg_segment_ptr 1
  .amdhsa_system_sgpr_workgroup_id_x 1
.end_amdhsa_kernel
```
